```python
import torch

def _softmax(x, axis=-1):
    return torch.softmax(x, dim=axis)
def _gelu(x):
    return torch.nn.functional.gelu(x, approximate="tanh")
def _silu(x):
    return torch.nn.functional.silu(x)
def _sigmoid(x):
    return torch.sigmoid(x)
def _layernorm(x, axis=-1, eps=1e-5):
    m = x.mean(dim=axis, keepdim=True)
    v = x.var(dim=axis, keepdim=True, unbiased=False)
    return (x - m) / torch.sqrt(v + eps)
def _scatter_add(tgt, idx, src, axis=0):
    return tgt.clone().index_add_(axis, idx, src)
def _segment_sum(src, seg, n):
    out = torch.zeros((n,) + src.shape[1:], dtype=src.dtype)
    return out.index_add_(0, seg, src)
def _pad(x, pw):
    flat = tuple(v for pair in reversed(pw) for v in pair)
    return torch.nn.functional.pad(x, flat)

kernel_name = 'gated_mix__linear_attn_block__dense_activation_silu__prompt'

def setup_inputs():

    _w = (lambda a: (lambda t: t.to(torch.bfloat16) if t.is_floating_point() else t)(torch.as_tensor(a)))
    def _A_setup():
        B, S, D = 1, 2048, 512
        return {
            "x": _w((lambda *s: torch.randn(*s, dtype=torch.bfloat16) * 0.1)(B, S, D)),
            "wqkv": _w((lambda *s: torch.randn(*s, dtype=torch.bfloat16) * 0.8)(D, 3 * D)),
            "wo": _w((lambda *s: torch.randn(*s, dtype=torch.bfloat16) * 0.4)(D, D)),
        }
    _A_in = _A_setup()

    def _B_setup():
        B, S, D, F = 1, 2048, 512, 1792
        return {
            "x": _w((lambda *s: torch.randn(*s, dtype=torch.bfloat16) * 0.1)(B, S, D)),
            "w1": _w((lambda *s: torch.randn(*s, dtype=torch.bfloat16) * 3.2)(D, F) * (D ** -0.5)),
            "w2": _w((lambda *s: torch.randn(*s, dtype=torch.bfloat16) * 3.2)(F, D) * (F ** -0.5)),
        }
    _B_in = _B_setup()

    return {
        "A_x": _A_in["x"],
        "A_wqkv": _A_in["wqkv"],
        "A_wo": _A_in["wo"],
        "B_x": _B_in["x"],
        "B_w1": _B_in["w1"],
        "B_w2": _B_in["w2"],
        "gate_w": _w((lambda *s: torch.randn(*s, dtype=torch.bfloat16) * 0.1)(512) * 16.0),
    }

def reference(A_x, A_wqkv, A_wo, B_x, B_w1, B_w2, gate_w):
    def _A_ref(x, wqkv, wo):
        B, S, D = x.shape
        H = 32; Dh = D // H
        qkv = (lambda x, *d: x.permute(*d))((x @ wqkv).reshape(B, S, 3, H, Dh), 2, 0, 3, 1, 4)
        q, k, v = qkv[0], qkv[1], qkv[2]
        phi = lambda t: torch.where(t > 0, t + 1, torch.exp(t)) + 1e-6
        pq, pk = phi(q), phi(k)
        kv = torch.einsum("bhsd,bhse->bhde", pk, v)
        z = torch.einsum("bhsd->bhd", pk)
        num = torch.einsum("bhqd,bhde->bhqe", pq, kv)
        den = torch.einsum("bhqd,bhd->bhq", pq, z)[..., None] + 1e-6
        o = num / den
        return (lambda x, *d: x.permute(*d))(o, 0, 2, 1, 3).reshape(B, S, D) @ wo

    def _B_ref(x, w1, w2):
        h = torch.einsum("bsd,df->bsf", x, w1)
        h = _silu(h)
        out = torch.einsum("bsf,fd->bsd", h, w2)
        return out

    x = A_x
    g = _sigmoid((x * gate_w).sum(-1, keepdims=True))
    a = _A_ref(x, A_wqkv, A_wo)
    b = _B_ref(x, B_w1, B_w2)
    return g * a + (1 - g) * b
```

```asm
; @launch grid=(256,1,1) block=(256,1,1) lds=163840
.amdgcn_target "amdgcn-amd-amdhsa--gfx950"
.text
.globl gated_mix__linear_attn_block__dense_activation_silu__prompt_kernel
.p2align 8
.type gated_mix__linear_attn_block__dense_activation_silu__prompt_kernel,@function
gated_mix__linear_attn_block__dense_activation_silu__prompt_kernel:
  s_cmpk_ge_u32 s2, 256
  s_cbranch_scc1 L_exit
  s_load_dwordx16 s[4:19], s[0:1], 0
  s_load_dwordx4 s[20:23], s[0:1], 64
  v_lshrrev_b32 v4, 6, v0
  v_and_b32 v1, 63, v0
  v_readfirstlane_b32 s36, v4
  v_lshrrev_b32 v4, 3, v1
  v_lshrrev_b32 v5, 4, v1
  v_and_b32 v6, 7, v1
  s_bfe_u32 s66, s2, 0x10000
  s_lshr_b32 s67, s2, 5
  s_lshl3_add_u32 s39, s66, s67
  v_xor_b32 v7, v5, v6
  v_lshlrev_b32 v7, 4, v7
  s_bfe_u32 s66, s2, 0x20003
  s_lshl1_add_u32 s47, s66, s67
  s_sub_u32 s47, 0, s47
  s_and_b32 s47, s47, 6
  s_lshr_b32 s68, s2, 1
  s_xor_b32 s68, s68, s2
  s_bfe_u32 s68, s68, 0x10000
  s_add_u32 s47, s47, s68
  v_lshl_add_u32 v186, v4, 10, v7
  v_xor_b32 v187, 64, v186
  s_lshl2_add_u32 s43, s39, s36
  s_lshl_b32 s43, s43, 8
  s_add_u32 s43, s43, s47
  s_lshl_b32 s43, s43, 7
  v_add_u32 v187, 7168, v187
  v_add_u32 v188, 14336, v186
  s_lshl_b32 s45, s36, 12
  s_and_b32 s66, s2, 6
  s_bfe_u32 s40, s2, 0x10004
  v_add_u32 v189, 14336, v187
  v_lshlrev_b32 v2, 4, v1
  s_add_u32 s40, s40, s66
  s_lshl2_add_u32 s44, s47, s36
  s_bitcmp1_b32 s2, 3
  s_cbranch_scc1 L_att
  v_mul_u32_u24 v9, 9363, v1
  s_movk_i32 s67, 3136
  v_add_u32 v11, 4096, v2
  v_lshrrev_b32 v10, 18, v9
  v_mad_u32_u24 v190, v10, s67, v2
  s_mul_i32 s44, s44, 57344
  v_add_u32 v9, 599232, v9
  v_lshrrev_b32 v10, 18, v9
  v_mad_u32_u24 v191, v10, s67, v2
  s_mul_i32 s66, s40, 448
  v_add_u32 v9, 599232, v9
  v_lshrrev_b32 v10, 18, v9
  v_mad_u32_u24 v192, v10, s67, v2
  s_add_u32 s44, s44, s66
  v_add_u32 v9, 599232, v9
  v_lshrrev_b32 v10, 18, v9
  v_mad_u32_u24 v193, v10, s67, v2
  s_mul_i32 s46, s36, 7168
  v_add_u32 v9, 599232, v9
  v_lshrrev_b32 v10, 18, v9
  v_mad_u32_u24 v194, v10, s67, v11
  v_add_u32 v9, 599232, v9
  v_lshrrev_b32 v10, 18, v9
  v_mad_u32_u24 v195, v10, s67, v11
  v_add_u32 v9, 599232, v9
  v_lshrrev_b32 v10, 18, v9
  v_mad_u32_u24 v196, v10, s67, v11
  s_waitcnt lgkmcnt(0)
  s_mov_b64 s[24:25], s[14:15]
  s_mov_b32 s6, 2097152
  s_mov_b32 s7, 0x20000
  s_mov_b32 s14, 1835008
  s_mov_b32 s15, 0x20000
  s_add_u32 m0, s45, 73728
  s_nop 0
  buffer_load_dwordx4 v186, s[4:7], s43 offen offset:0 lds
  buffer_load_dwordx4 v187, s[4:7], s43 offen offset:1024 lds
  s_cmp_eq_u32 s47, 7
  s_cselect_b32 s49, -7, 1
  buffer_load_dwordx4 v188, s[4:7], s43 offen offset:2048 lds
  s_lshl_b32 s87, s49, 7
  buffer_load_dwordx4 v189, s[4:7], s43 offen offset:3072 lds
  s_add_u32 s43, s43, s87
  s_add_u32 m0, s46, 90112
  s_nop 0
  buffer_load_dwordx4 v190, s[12:15], s44 offen offset:0 lds
  buffer_load_dwordx4 v191, s[12:15], s44 offen offset:1024 lds
  s_mul_i32 s49, s49, 229376
  buffer_load_dwordx4 v192, s[12:15], s44 offen offset:2048 lds
  buffer_load_dwordx4 v193, s[12:15], s44 offen offset:3072 lds
  s_add_u32 m0, s46, 94208
  s_nop 0
  buffer_load_dwordx4 v194, s[12:15], s44 offen offset:0 lds
  buffer_load_dwordx4 v195, s[12:15], s44 offen offset:1024 lds
  buffer_load_dwordx4 v196, s[12:15], s44 offen offset:2048 lds
  s_add_u32 s44, s44, s49
  s_getpc_b64 s[66:67]
L_pc_ffn:
  s_lshr_b32 s69, s2, 4
  s_lshl_b32 s69, s69, 11
  s_add_u32 s69, s69, L_ffn_rest-L_pc_ffn
  v_lshrrev_b32 v10, 4, v0
  v_and_b32 v11, 3, v0
  v_add_u32 v10, v10, v11
  v_lshl_add_u32 v10, v10, 7, s69
  v_min_u32 v10, L_att_rest-L_pc_ffn, v10
  v_mov_b32 v11, s67
  v_add_co_u32 v10, vcc, s66, v10
  s_nop 1
  v_addc_co_u32 v11, vcc, 0, v11, vcc
  s_mov_b64 exec, 0xf
  global_load_dword v252, v[10:11], off
  s_mov_b64 exec, -1
  v_lshlrev_b32 v8, 2, v5
  v_and_b32 v8, 4, v8
  v_xor_b32 v8, v8, v6
  v_lshlrev_b32 v8, 4, v8
  s_branch L_ffn_rest
L_att:
  v_lshlrev_b32 v8, 2, v5
  v_and_b32 v8, 4, v8
  v_xor_b32 v8, v8, v6
  v_lshlrev_b32 v8, 4, v8
  v_mul_u32_u24 v9, 3072, v4
  v_add_u32 v9, v9, v8
  v_add_u32 v190, 1024, v9
  s_mul_i32 s44, s44, 49152
  v_add_u32 v191, 24576, v9
  s_mul_i32 s66, s40, 128
  v_add_u32 v192, 0, v9
  s_add_u32 s44, s44, s66
  v_add_u32 v193, 23552, v9
  s_mul_i32 s46, s36, 6144
  v_add_u32 v194, 0, v9
  v_add_u32 v195, 23552, v9
  s_waitcnt lgkmcnt(0)
  s_mov_b64 s[88:89], s[6:7]
  s_mov_b32 s6, 2097152
  s_mov_b32 s7, 0x20000
  s_mov_b32 s90, 1572864
  s_mov_b32 s91, 0x20000
  s_add_u32 m0, s45, 73728
  s_nop 0
  buffer_load_dwordx4 v186, s[4:7], s43 offen offset:0 lds
  buffer_load_dwordx4 v187, s[4:7], s43 offen offset:1024 lds
  s_cmp_eq_u32 s47, 7
  s_cselect_b32 s49, -7, 1
  buffer_load_dwordx4 v188, s[4:7], s43 offen offset:2048 lds
  s_lshl_b32 s87, s49, 7
  buffer_load_dwordx4 v189, s[4:7], s43 offen offset:3072 lds
  s_add_u32 s43, s43, s87
  s_add_u32 m0, s46, 90112
  s_nop 0
  buffer_load_dwordx4 v190, s[88:91], s44 offen offset:0 lds
  buffer_load_dwordx4 v191, s[88:91], s44 offen offset:1024 lds
  s_mul_i32 s49, s49, 196608
  buffer_load_dwordx4 v192, s[88:91], s44 offen offset:2048 lds
  buffer_load_dwordx4 v193, s[88:91], s44 offen offset:3072 lds
  s_add_u32 m0, s46, 94208
  s_nop 0
  buffer_load_dwordx4 v194, s[88:91], s44 offen offset:0 lds
  buffer_load_dwordx4 v195, s[88:91], s44 offen offset:1024 lds
  s_add_u32 s44, s44, s49
  s_getpc_b64 s[66:67]
L_pc_att:
  s_lshr_b32 s69, s2, 4
  s_lshl_b32 s69, s69, 11
  s_add_u32 s69, s69, L_att_rest-L_pc_att
  v_lshrrev_b32 v10, 4, v0
  v_and_b32 v11, 3, v0
  v_add_u32 v10, v10, v11
  v_lshl_add_u32 v10, v10, 7, s69
  v_min_u32 v10, L_exit-L_pc_att, v10
  v_mov_b32 v11, s67
  v_add_co_u32 v10, vcc, s66, v10
  s_nop 1
  v_addc_co_u32 v11, vcc, 0, v11, vcc
  s_mov_b64 exec, 0xf
  global_load_dword v252, v[10:11], off
  s_mov_b64 exec, -1
  s_branch L_att_rest
L_ffn_rest:
  s_mov_b64 s[32:33], s[18:19]
  s_mov_b64 s[28:29], s[22:23]
  s_lshr_b32 s37, s36, 1
  s_and_b32 s38, s36, 1
  v_and_b32 v10, 31, v1
  v_lshrrev_b32 v11, 5, v1
  v_bfe_u32 v12, v1, 1, 3
  v_xor_b32 v12, v12, v11
  v_lshlrev_b32 v12, 4, v12
  v_lshl_add_u32 v12, v10, 7, v12
  s_add_u32 s66, s45, 73728
  s_xor_b32 s67, s45, 4096
  s_add_u32 s67, s67, 73728
  v_xor_b32 v13, 0, v12
  v_add_u32 v176, s66, v13
  v_add_u32 v180, s67, v13
  v_xor_b32 v13, 32, v12
  v_add_u32 v177, s66, v13
  v_add_u32 v181, s67, v13
  v_xor_b32 v13, 64, v12
  v_add_u32 v178, s66, v13
  v_add_u32 v182, s67, v13
  v_xor_b32 v13, 96, v12
  v_add_u32 v179, s66, v13
  v_add_u32 v183, s67, v13
  v_bfe_u32 v13, v1, 2, 2
  v_bfe_u32 v14, v1, 4, 1
  v_lshlrev_b32 v14, 5, v14
  v_and_b32 v15, 3, v1
  v_lshl_add_u32 v14, v15, 3, v14
  v_lshl_add_u32 v15, v11, 3, v13
  v_mul_u32_u24 v15, 448, v15
  v_add_u32 v15, v15, v14
  v_add_u32 v185, 90304, v15
  s_mul_i32 s66, s38, 320
  s_add_u32 s66, s66, 90112
  v_add_u32 v184, s66, v15
  s_lshl_b32 s66, s38, 7
  s_add_u32 s66, s66, 90240
  v_add_u32 v248, s66, v15
  s_mov_b32 s30, 17825792
  s_mov_b32 s31, 0x20000
  s_mov_b32 s26, 1835008
  s_mov_b32 s27, 0x20000
  s_mov_b32 s10, 524288
  s_mov_b32 s11, 0x20000
  s_mov_b32 s22, 256
  s_mov_b32 s23, 0x20000
  s_mov_b32 s18, 1024
  s_mov_b32 s19, 0x20000
  v_mov_b32 v3, 0
  s_or_b32 s66, s2, s36
  s_cmp_eq_u32 s66, 0
  s_cselect_b32 s84, 1, 0
  s_mov_b32 s85, 0
  s_add_u32 m0, s45, 118784
  s_nop 0
  buffer_load_dwordx4 v186, s[4:7], s43 offen offset:0 lds
  buffer_load_dwordx4 v187, s[4:7], s43 offen offset:1024 lds
  s_cmp_eq_u32 s47, 6
  s_cselect_b32 s49, -7, 1
  buffer_load_dwordx4 v188, s[4:7], s43 offen offset:2048 lds
  s_lshl_b32 s87, s49, 7
  buffer_load_dwordx4 v189, s[4:7], s43 offen offset:3072 lds
  s_add_u32 s43, s43, s87
  s_add_u32 m0, s46, 135168
  s_nop 0
  buffer_load_dwordx4 v190, s[12:15], s44 offen offset:0 lds
  buffer_load_dwordx4 v191, s[12:15], s44 offen offset:1024 lds
  s_mul_i32 s49, s49, 229376
  buffer_load_dwordx4 v192, s[12:15], s44 offen offset:2048 lds
  buffer_load_dwordx4 v193, s[12:15], s44 offen offset:3072 lds
  s_add_u32 m0, s46, 139264
  s_nop 0
  buffer_load_dwordx4 v194, s[12:15], s44 offen offset:0 lds
  buffer_load_dwordx4 v195, s[12:15], s44 offen offset:1024 lds
  buffer_load_dwordx4 v196, s[12:15], s44 offen offset:2048 lds
  s_add_u32 s44, s44, s49
  s_lshr_b32 s68, s2, 3
  s_and_b32 s69, s2, 3
  s_lshl2_add_u32 s68, s68, s69
  s_lshl2_add_u32 s68, s68, s36
  s_mul_i32 s69, s68, 3584
  v_lshl_add_u32 v249, v1, 7, s69
  s_lshl_b32 s68, s68, 10
  v_lshl_add_u32 v250, v1, 7, s68
  s_mov_b64 exec, s[84:85]
  buffer_load_dword v251, v3, s[28:31], 0 offen sc1
  s_mov_b64 exec, -1
  s_waitcnt vmcnt(13)
  s_barrier
  ds_read_b128 v[128:131], v176
  ds_read_b64_tr_b16 v[144:145], v184 offset:0
  ds_read_b64_tr_b16 v[146:147], v184 offset:1792
  ds_read_b128 v[136:139], v180
  ds_read_b64_tr_b16 v[148:149], v184 offset:64
  ds_read_b64_tr_b16 v[150:151], v184 offset:1856
  ds_read_b64_tr_b16 v[152:153], v248 offset:0
  ds_read_b64_tr_b16 v[154:155], v248 offset:1792
  ds_read_b64_tr_b16 v[156:157], v185 offset:0
  ds_read_b64_tr_b16 v[158:159], v185 offset:1792
  s_waitcnt lgkmcnt(4)
  v_mfma_f32_32x32x16_bf16 v[16:31], v[144:147], v[128:131], 0
  ds_read_b128 v[132:135], v177
  ds_read_b64_tr_b16 v[160:161], v184 offset:7168
  v_add_u32 v176, 0xb000, v176
  v_mfma_f32_32x32x16_bf16 v[32:47], v[144:147], v[136:139], 0
  s_add_u32 m0, s45, 0
  ds_read_b64_tr_b16 v[162:163], v184 offset:8960
  ds_read_b128 v[140:143], v181
  buffer_load_dwordx4 v186, s[4:7], s43 offen offset:0 lds
  v_mfma_f32_32x32x16_bf16 v[48:63], v[148:151], v[128:131], 0
  ds_read_b64_tr_b16 v[164:165], v184 offset:7232
  ds_read_b64_tr_b16 v[166:167], v184 offset:9024
  v_add_u32 v180, 0xb000, v180
  v_mfma_f32_32x32x16_bf16 v[64:79], v[148:151], v[136:139], 0
  ds_read_b64_tr_b16 v[168:169], v248 offset:7168
  ds_read_b64_tr_b16 v[170:171], v248 offset:8960
  buffer_load_dwordx4 v187, s[4:7], s43 offen offset:1024 lds
  s_cmp_eq_u32 s47, 5
  s_cselect_b32 s49, -7, 1
  s_waitcnt lgkmcnt(8)
  v_mfma_f32_32x32x16_bf16 v[80:95], v[152:155], v[128:131], 0
  ds_read_b64_tr_b16 v[172:173], v185 offset:7168
  ds_read_b64_tr_b16 v[174:175], v185 offset:8960
  v_add_u32 v177, 0xb000, v177
  v_add_u32 v181, 0xb000, v181
  v_mfma_f32_32x32x16_bf16 v[96:111], v[152:155], v[136:139], 0
  buffer_load_dwordx4 v188, s[4:7], s43 offen offset:2048 lds
  s_lshl_b32 s87, s49, 7
  v_mfma_f32_32x32x16_bf16 v[112:127], v[156:159], v[128:131], 0
  buffer_load_dwordx4 v189, s[4:7], s43 offen offset:3072 lds
  s_add_u32 s43, s43, s87
  s_waitcnt lgkmcnt(4)
  v_mfma_f32_32x32x16_bf16 v[16:31], v[160:163], v[132:135], v[16:31]
  ds_read_b128 v[128:131], v178
  ds_read_b64_tr_b16 v[144:145], v184 offset:14336
  s_mov_b32 s62, 0xffff0000
  s_mov_b32 s63, 0xffff0000
  v_mfma_f32_32x32x16_bf16 v[32:47], v[160:163], v[140:143], v[32:47]
  s_add_u32 m0, s46, 16384
  ds_read_b64_tr_b16 v[146:147], v184 offset:16128
  ds_read_b128 v[136:139], v182
  buffer_load_dwordx4 v190, s[12:15], s44 offen offset:0 lds
  v_mfma_f32_32x32x16_bf16 v[48:63], v[164:167], v[132:135], v[48:63]
  ds_read_b64_tr_b16 v[148:149], v184 offset:14400
  ds_read_b64_tr_b16 v[150:151], v184 offset:16192
  s_mov_b32 s56, 0xbfb8aa3b
  s_mov_b32 s57, 0xbfb8aa3b
  v_mfma_f32_32x32x16_bf16 v[64:79], v[164:167], v[140:143], v[64:79]
  ds_read_b64_tr_b16 v[152:153], v248 offset:14336
  ds_read_b64_tr_b16 v[154:155], v248 offset:16128
  buffer_load_dwordx4 v191, s[12:15], s44 offen offset:1024 lds
  s_mul_i32 s49, s49, 229376
  s_waitcnt lgkmcnt(8)
  v_mfma_f32_32x32x16_bf16 v[80:95], v[168:171], v[132:135], v[80:95]
  ds_read_b64_tr_b16 v[156:157], v185 offset:14336
  ds_read_b64_tr_b16 v[158:159], v185 offset:16128
  v_add_u32 v178, 0xb000, v178
  v_add_u32 v182, 0xb000, v182
  v_mfma_f32_32x32x16_bf16 v[96:111], v[168:171], v[140:143], v[96:111]
  buffer_load_dwordx4 v192, s[12:15], s44 offen offset:2048 lds
  s_mov_b32 s58, 0x3f800000
  s_mov_b32 s59, 0x3f800000
  s_mov_b32 s60, 0x358637bd
  v_mfma_f32_32x32x16_bf16 v[112:127], v[172:175], v[132:135], v[112:127]
  buffer_load_dwordx4 v193, s[12:15], s44 offen offset:3072 lds
  s_mov_b32 s61, 0x358637bd
  s_mov_b32 s64, 0x3fb8aa3b
  s_mov_b32 s65, 0x3fb8aa3b
  s_waitcnt lgkmcnt(4)
  v_mfma_f32_32x32x16_bf16 v[16:31], v[144:147], v[128:131], v[16:31]
  ds_read_b128 v[132:135], v179
  ds_read_b64_tr_b16 v[160:161], v184 offset:21504
  s_mov_b32 s86, 0x3f80
  s_mov_b32 s75, 524288
  v_mfma_f32_32x32x16_bf16 v[32:47], v[144:147], v[136:139], v[32:47]
  s_add_u32 m0, s46, 20480
  ds_read_b64_tr_b16 v[162:163], v184 offset:23296
  ds_read_b128 v[140:143], v183
  buffer_load_dwordx4 v194, s[12:15], s44 offen offset:0 lds
  v_mfma_f32_32x32x16_bf16 v[48:63], v[148:151], v[128:131], v[48:63]
  ds_read_b64_tr_b16 v[164:165], v184 offset:21568
  ds_read_b64_tr_b16 v[166:167], v184 offset:23360
  s_mov_b32 s34, 2097152
  s_mov_b32 s35, 0x20000
  v_mfma_f32_32x32x16_bf16 v[64:79], v[148:151], v[136:139], v[64:79]
  ds_read_b64_tr_b16 v[168:169], v248 offset:21504
  ds_read_b64_tr_b16 v[170:171], v248 offset:23296
  buffer_load_dwordx4 v195, s[12:15], s44 offen offset:1024 lds
  s_bfe_u32 s41, s2, 0x20001
  s_waitcnt lgkmcnt(8)
  v_mfma_f32_32x32x16_bf16 v[80:95], v[152:155], v[128:131], v[80:95]
  ds_read_b64_tr_b16 v[172:173], v185 offset:21504
  ds_read_b64_tr_b16 v[174:175], v185 offset:23296
  v_add_u32 v179, 0xb000, v179
  v_add_u32 v183, 0xb000, v183
  v_mfma_f32_32x32x16_bf16 v[96:111], v[152:155], v[136:139], v[96:111]
  buffer_load_dwordx4 v196, s[12:15], s44 offen offset:2048 lds
  s_add_u32 s44, s44, s49
  v_add_u32 v184, 0xb000, v184
  v_add_u32 v248, 0xb000, v248
  v_mfma_f32_32x32x16_bf16 v[112:127], v[156:159], v[128:131], v[112:127]
  v_add_u32 v185, 0xb000, v185
  s_lshr_b32 s66, s2, 5
  s_lshl3_add_u32 s41, s41, s66
  s_and_b32 s42, s2, 1
  s_waitcnt lgkmcnt(0)
  v_mfma_f32_32x32x16_bf16 v[16:31], v[160:163], v[132:135], v[16:31]
  s_bfe_u32 s66, s2, 0x20003
  s_lshl2_add_u32 s42, s42, s66
  v_lshl_add_u32 v197, v4, 10, v8
  v_add_u32 v198, 7168, v197
  v_mfma_f32_32x32x16_bf16 v[32:47], v[160:163], v[140:143], v[32:47]
  s_waitcnt vmcnt(12)
  s_barrier
  ds_read_b128 v[128:131], v176
  ds_read_b64_tr_b16 v[144:145], v184 offset:0
  s_mul_i32 s100, s36, 458752
  v_mfma_f32_32x32x16_bf16 v[48:63], v[164:167], v[132:135], v[48:63]
  ds_read_b64_tr_b16 v[146:147], v184 offset:1792
  ds_read_b128 v[136:139], v180
  s_lshl_b32 s66, s42, 7
  s_add_u32 s100, s100, s66
  v_mfma_f32_32x32x16_bf16 v[64:79], v[164:167], v[140:143], v[64:79]
  ds_read_b64_tr_b16 v[148:149], v184 offset:64
  ds_read_b64_tr_b16 v[150:151], v184 offset:1856
  s_lshl_b32 s54, s36, 17
  s_add_u32 s54, s54, s66
  v_mfma_f32_32x32x16_bf16 v[80:95], v[168:171], v[132:135], v[80:95]
  ds_read_b64_tr_b16 v[152:153], v248 offset:0
  ds_read_b64_tr_b16 v[154:155], v248 offset:1792
  s_add_u32 s48, s41, s42
  s_mul_i32 s48, s48, -1
  v_mfma_f32_32x32x16_bf16 v[96:111], v[168:171], v[140:143], v[96:111]
  ds_read_b64_tr_b16 v[156:157], v185 offset:0
  ds_read_b64_tr_b16 v[158:159], v185 offset:1792
  s_and_b32 s48, s48, 3
  s_lshl_b32 s68, s48, 3
  v_mfma_f32_32x32x16_bf16 v[112:127], v[172:175], v[132:135], v[112:127]
  s_mov_b32 s66, 0x180e0a00
  s_mov_b32 s67, 0x180e0a00
  s_lshr_b64 s[66:67], s[66:67], s68
  s_mov_b32 s48, s66
  s_waitcnt lgkmcnt(4)
  v_mfma_f32_32x32x16_bf16 v[16:31], v[144:147], v[128:131], v[16:31]
  ds_read_b128 v[132:135], v177
  ds_read_b64_tr_b16 v[160:161], v184 offset:7168
  v_add_u32 v176, 0xfffe3000, v176
  s_mov_b32 s66, 0x15120704
  v_mfma_f32_32x32x16_bf16 v[32:47], v[144:147], v[136:139], v[32:47]
  s_add_u32 m0, s45, 73728
  ds_read_b64_tr_b16 v[162:163], v184 offset:8960
  ds_read_b128 v[140:143], v181
  buffer_load_dwordx4 v186, s[4:7], s43 offen offset:0 lds
  v_mfma_f32_32x32x16_bf16 v[48:63], v[148:151], v[128:131], v[48:63]
  ds_read_b64_tr_b16 v[164:165], v184 offset:7232
  ds_read_b64_tr_b16 v[166:167], v184 offset:9024
  v_add_u32 v180, 0xfffe3000, v180
  s_mov_b32 s67, 0x15120704
  v_mfma_f32_32x32x16_bf16 v[64:79], v[148:151], v[136:139], v[64:79]
  ds_read_b64_tr_b16 v[168:169], v248 offset:7168
  ds_read_b64_tr_b16 v[170:171], v248 offset:8960
  buffer_load_dwordx4 v187, s[4:7], s43 offen offset:1024 lds
  s_cmp_eq_u32 s47, 4
  s_cselect_b32 s49, -7, 1
  s_waitcnt lgkmcnt(8)
  v_mfma_f32_32x32x16_bf16 v[80:95], v[152:155], v[128:131], v[80:95]
  ds_read_b64_tr_b16 v[172:173], v185 offset:7168
  ds_read_b64_tr_b16 v[174:175], v185 offset:8960
  v_add_u32 v177, 0xfffe3000, v177
  v_add_u32 v181, 0xfffe3000, v181
  v_mfma_f32_32x32x16_bf16 v[96:111], v[152:155], v[136:139], v[96:111]
  buffer_load_dwordx4 v188, s[4:7], s43 offen offset:2048 lds
  s_lshl_b32 s87, s49, 7
  s_lshr_b64 s[66:67], s[66:67], s68
  s_mov_b32 s0, s66
  v_mfma_f32_32x32x16_bf16 v[112:127], v[156:159], v[128:131], v[112:127]
  buffer_load_dwordx4 v189, s[4:7], s43 offen offset:3072 lds
  s_add_u32 s43, s43, s87
  s_mov_b32 s66, 0x6040200
  s_mov_b32 s67, 0x6040200
  s_waitcnt lgkmcnt(4)
  v_mfma_f32_32x32x16_bf16 v[16:31], v[160:163], v[132:135], v[16:31]
  ds_read_b128 v[128:131], v178
  ds_read_b64_tr_b16 v[144:145], v184 offset:14336
  s_lshr_b64 s[66:67], s[66:67], s68
  s_mov_b32 s1, s66
  v_mfma_f32_32x32x16_bf16 v[32:47], v[160:163], v[140:143], v[32:47]
  s_add_u32 m0, s46, 90112
  ds_read_b64_tr_b16 v[146:147], v184 offset:16128
  ds_read_b128 v[136:139], v182
  buffer_load_dwordx4 v190, s[12:15], s44 offen offset:0 lds
  v_mfma_f32_32x32x16_bf16 v[48:63], v[164:167], v[132:135], v[48:63]
  ds_read_b64_tr_b16 v[148:149], v184 offset:14400
  ds_read_b64_tr_b16 v[150:151], v184 offset:16192
  s_lshl_b32 s52, s36, 14
  s_mul_i32 s53, s36, 10240
  v_mfma_f32_32x32x16_bf16 v[64:79], v[164:167], v[140:143], v[64:79]
  ds_read_b64_tr_b16 v[152:153], v248 offset:14336
  ds_read_b64_tr_b16 v[154:155], v248 offset:16128
  buffer_load_dwordx4 v191, s[12:15], s44 offen offset:1024 lds
  s_mul_i32 s49, s49, 229376
  s_waitcnt lgkmcnt(8)
  v_mfma_f32_32x32x16_bf16 v[80:95], v[168:171], v[132:135], v[80:95]
  ds_read_b64_tr_b16 v[156:157], v185 offset:14336
  ds_read_b64_tr_b16 v[158:159], v185 offset:16128
  v_add_u32 v178, 0xfffe3000, v178
  v_add_u32 v182, 0xfffe3000, v182
  v_mfma_f32_32x32x16_bf16 v[96:111], v[168:171], v[140:143], v[96:111]
  buffer_load_dwordx4 v192, s[12:15], s44 offen offset:2048 lds
  s_add_u32 s53, s53, 73728
  v_lshl_add_u32 v15, v11, 2, v13
  v_lshl_add_u32 v15, v15, 7, v14
  v_mfma_f32_32x32x16_bf16 v[112:127], v[172:175], v[132:135], v[112:127]
  buffer_load_dwordx4 v193, s[12:15], s44 offen offset:3072 lds
  v_lshrrev_b32 v9, 1, v13
  v_lshl_add_u32 v15, v9, 6, v15
  v_add_u32 v199, s52, v15
  s_waitcnt lgkmcnt(4)
  v_mfma_f32_32x32x16_bf16 v[16:31], v[144:147], v[128:131], v[16:31]
  ds_read_b128 v[132:135], v179
  ds_read_b64_tr_b16 v[160:161], v184 offset:21504
  v_add_u32 v201, s53, v15
  v_xor_b32 v15, 64, v15
  v_mfma_f32_32x32x16_bf16 v[32:47], v[144:147], v[136:139], v[32:47]
  s_add_u32 m0, s46, 94208
  ds_read_b64_tr_b16 v[162:163], v184 offset:23296
  ds_read_b128 v[140:143], v183
  buffer_load_dwordx4 v194, s[12:15], s44 offen offset:0 lds
  v_mfma_f32_32x32x16_bf16 v[48:63], v[148:151], v[128:131], v[48:63]
  ds_read_b64_tr_b16 v[164:165], v184 offset:21568
  ds_read_b64_tr_b16 v[166:167], v184 offset:23360
  v_add_u32 v200, s52, v15
  v_add_u32 v202, s53, v15
  v_mfma_f32_32x32x16_bf16 v[64:79], v[148:151], v[136:139], v[64:79]
  ds_read_b64_tr_b16 v[168:169], v248 offset:21504
  ds_read_b64_tr_b16 v[170:171], v248 offset:23296
  buffer_load_dwordx4 v195, s[12:15], s44 offen offset:1024 lds
  s_lshl1_add_u32 s66, s39, s37
  s_waitcnt lgkmcnt(8)
  v_mfma_f32_32x32x16_bf16 v[80:95], v[152:155], v[128:131], v[80:95]
  ds_read_b64_tr_b16 v[172:173], v185 offset:21504
  ds_read_b64_tr_b16 v[174:175], v185 offset:23296
  v_add_u32 v179, 0xfffe3000, v179
  v_add_u32 v183, 0xfffe3000, v183
  v_mfma_f32_32x32x16_bf16 v[96:111], v[152:155], v[136:139], v[96:111]
  buffer_load_dwordx4 v196, s[12:15], s44 offen offset:2048 lds
  s_add_u32 s44, s44, s49
  v_add_u32 v184, 0xfffe3000, v184
  v_add_u32 v248, 0xfffe3000, v248
  v_mfma_f32_32x32x16_bf16 v[112:127], v[156:159], v[128:131], v[112:127]
  v_add_u32 v185, 0xfffe3000, v185
  s_lshl3_add_u32 s66, s66, s40
  s_lshl1_add_u32 s66, s66, s38
  s_lshl_b32 s66, s66, 7
  s_waitcnt lgkmcnt(0)
  v_mfma_f32_32x32x16_bf16 v[16:31], v[160:163], v[132:135], v[16:31]
  s_add_u32 s93, s66, 65536
  s_lshl2_add_u32 s67, s39, s36
  s_xor_b32 s68, s67, 1
  s_mul_i32 s67, s67, 147456
  v_mfma_f32_32x32x16_bf16 v[32:47], v[160:163], v[140:143], v[32:47]
  s_waitcnt vmcnt(11)
  s_barrier
  ds_read_b128 v[128:131], v176
  ds_read_b64_tr_b16 v[144:145], v184 offset:0
  s_mul_i32 s68, s68, 147456
  v_mfma_f32_32x32x16_bf16 v[48:63], v[164:167], v[132:135], v[48:63]
  ds_read_b64_tr_b16 v[146:147], v184 offset:1792
  ds_read_b128 v[136:139], v180
  s_mul_i32 s66, s40, 14336
  s_add_u32 s66, s66, 2097152
  v_mfma_f32_32x32x16_bf16 v[64:79], v[164:167], v[140:143], v[64:79]
  ds_read_b64_tr_b16 v[148:149], v184 offset:64
  ds_read_b64_tr_b16 v[150:151], v184 offset:1856
  s_add_u32 s72, s67, s66
  s_mul_i32 s69, s38, 10240
  v_mfma_f32_32x32x16_bf16 v[80:95], v[168:171], v[132:135], v[80:95]
  ds_read_b64_tr_b16 v[152:153], v248 offset:0
  ds_read_b64_tr_b16 v[154:155], v248 offset:1792
  s_add_u32 s70, s72, s69
  s_add_u32 s71, s68, s66
  v_mfma_f32_32x32x16_bf16 v[96:111], v[168:171], v[140:143], v[96:111]
  ds_read_b64_tr_b16 v[156:157], v185 offset:0
  ds_read_b64_tr_b16 v[158:159], v185 offset:1792
  s_add_u32 s71, s71, s69
  s_add_u32 s72, s72, 6144
  v_mfma_f32_32x32x16_bf16 v[112:127], v[172:175], v[132:135], v[112:127]
  s_bitcmp0_b32 s2, 2
  s_cselect_b64 exec, 0xfffffff, 0
  buffer_load_dword v253, v249, s[24:27], 0 offen
  s_bitcmp0_b32 s2, 2
  s_cselect_b64 exec, 0xff, 0
  buffer_load_dword v254, v250, s[8:11], 0 offen
  s_mov_b64 exec, -1
  s_waitcnt lgkmcnt(4)
  v_mfma_f32_32x32x16_bf16 v[16:31], v[144:147], v[128:131], v[16:31]
  ds_read_b128 v[132:135], v177
  ds_read_b64_tr_b16 v[160:161], v184 offset:7168
  v_add_u32 v176, 0x12000, v176
  v_and_b32 v203, 3, v1
  v_mfma_f32_32x32x16_bf16 v[32:47], v[144:147], v[136:139], v[32:47]
  s_add_u32 m0, s45, 118784
  ds_read_b64_tr_b16 v[162:163], v184 offset:8960
  ds_read_b128 v[140:143], v181
  buffer_load_dwordx4 v186, s[4:7], s43 offen offset:0 lds
  v_mfma_f32_32x32x16_bf16 v[48:63], v[148:151], v[128:131], v[48:63]
  ds_read_b64_tr_b16 v[164:165], v184 offset:7232
  ds_read_b64_tr_b16 v[166:167], v184 offset:9024
  v_add_u32 v180, 0x12000, v180
  v_lshlrev_b32 v203, 7, v203
  v_mfma_f32_32x32x16_bf16 v[64:79], v[148:151], v[136:139], v[64:79]
  ds_read_b64_tr_b16 v[168:169], v248 offset:7168
  ds_read_b64_tr_b16 v[170:171], v248 offset:8960
  buffer_load_dwordx4 v187, s[4:7], s43 offen offset:1024 lds
  s_cmp_eq_u32 s47, 3
  s_cselect_b32 s49, -7, 1
  s_waitcnt lgkmcnt(8)
  v_mfma_f32_32x32x16_bf16 v[80:95], v[152:155], v[128:131], v[80:95]
  ds_read_b64_tr_b16 v[172:173], v185 offset:7168
  ds_read_b64_tr_b16 v[174:175], v185 offset:8960
  v_add_u32 v177, 0x12000, v177
  v_add_u32 v181, 0x12000, v181
  v_mfma_f32_32x32x16_bf16 v[96:111], v[152:155], v[136:139], v[96:111]
  buffer_load_dwordx4 v188, s[4:7], s43 offen offset:2048 lds
  s_lshl_b32 s87, s49, 7
  s_lshl2_add_u32 s66, s41, s36
  s_lshl_b32 s66, s66, 9
  v_mfma_f32_32x32x16_bf16 v[112:127], v[156:159], v[128:131], v[112:127]
  buffer_load_dwordx4 v189, s[4:7], s43 offen offset:3072 lds
  s_add_u32 s43, s43, s87
  s_add_u32 s94, s66, 65536
  s_add_u32 s95, s66, 131072
  s_waitcnt lgkmcnt(4)
  v_mfma_f32_32x32x16_bf16 v[16:31], v[160:163], v[132:135], v[16:31]
  ds_read_b128 v[128:131], v178
  ds_read_b64_tr_b16 v[144:145], v184 offset:14336
  v_add_u32 v251, 1, v251
  v_max_u32 v251, 1, v251
  v_mfma_f32_32x32x16_bf16 v[32:47], v[160:163], v[140:143], v[32:47]
  s_add_u32 m0, s46, 135168
  ds_read_b64_tr_b16 v[146:147], v184 offset:16128
  ds_read_b128 v[136:139], v182
  buffer_load_dwordx4 v190, s[12:15], s44 offen offset:0 lds
  v_mfma_f32_32x32x16_bf16 v[48:63], v[164:167], v[132:135], v[48:63]
  ds_read_b64_tr_b16 v[148:149], v184 offset:14400
  ds_read_b64_tr_b16 v[150:151], v184 offset:16192
  s_mov_b64 exec, s[84:85]
  buffer_store_dword v251, v3, s[20:23], 0 offen sc1
  buffer_store_dword v251, v3, s[28:31], 0 offen sc1
  s_mov_b64 exec, -1
  v_mfma_f32_32x32x16_bf16 v[64:79], v[164:167], v[140:143], v[64:79]
  ds_read_b64_tr_b16 v[152:153], v248 offset:14336
  ds_read_b64_tr_b16 v[154:155], v248 offset:16128
  buffer_load_dwordx4 v191, s[12:15], s44 offen offset:1024 lds
  s_mul_i32 s49, s49, 229376
  s_waitcnt lgkmcnt(8)
  v_mfma_f32_32x32x16_bf16 v[80:95], v[168:171], v[132:135], v[80:95]
  ds_read_b64_tr_b16 v[156:157], v185 offset:14336
  ds_read_b64_tr_b16 v[158:159], v185 offset:16128
  v_add_u32 v178, 0x12000, v178
  v_add_u32 v182, 0x12000, v182
  v_mfma_f32_32x32x16_bf16 v[96:111], v[168:171], v[140:143], v[96:111]
  buffer_load_dwordx4 v192, s[12:15], s44 offen offset:2048 lds
  s_mul_i32 s96, s41, 294912
  s_add_u32 s96, s96, 2211840
  s_lshl_b32 s66, s36, 13
  v_mfma_f32_32x32x16_bf16 v[112:127], v[172:175], v[132:135], v[112:127]
  buffer_load_dwordx4 v193, s[12:15], s44 offen offset:3072 lds
  s_add_u32 s96, s96, s66
  s_lshl_b32 s66, s42, 7
  s_lshl_b32 s98, s41, 16
  s_waitcnt lgkmcnt(4)
  v_mfma_f32_32x32x16_bf16 v[16:31], v[144:147], v[128:131], v[16:31]
  ds_read_b128 v[132:135], v179
  ds_read_b64_tr_b16 v[160:161], v184 offset:21504
  s_add_u32 s98, s98, s66
  s_add_u32 s98, s98, s52
  v_mfma_f32_32x32x16_bf16 v[32:47], v[144:147], v[136:139], v[32:47]
  s_add_u32 m0, s46, 139264
  ds_read_b64_tr_b16 v[162:163], v184 offset:23296
  ds_read_b128 v[140:143], v183
  buffer_load_dwordx4 v194, s[12:15], s44 offen offset:0 lds
  v_mfma_f32_32x32x16_bf16 v[48:63], v[148:151], v[128:131], v[48:63]
  ds_read_b64_tr_b16 v[164:165], v184 offset:21568
  ds_read_b64_tr_b16 v[166:167], v184 offset:23360
  s_add_u32 s99, s98, 8192
  s_lshl_b32 s66, s36, 15
  v_mfma_f32_32x32x16_bf16 v[64:79], v[148:151], v[136:139], v[64:79]
  ds_read_b64_tr_b16 v[168:169], v248 offset:21504
  ds_read_b64_tr_b16 v[170:171], v248 offset:23296
  buffer_load_dwordx4 v195, s[12:15], s44 offen offset:1024 lds
  s_lshl_b32 s68, s41, 8
  s_waitcnt lgkmcnt(8)
  v_mfma_f32_32x32x16_bf16 v[80:95], v[152:155], v[128:131], v[80:95]
  ds_read_b64_tr_b16 v[172:173], v185 offset:21504
  ds_read_b64_tr_b16 v[174:175], v185 offset:23296
  v_add_u32 v179, 0x12000, v179
  v_add_u32 v183, 0x12000, v183
  v_mfma_f32_32x32x16_bf16 v[96:111], v[152:155], v[136:139], v[96:111]
  buffer_load_dwordx4 v196, s[12:15], s44 offen offset:2048 lds
  s_add_u32 s44, s44, s49
  v_add_u32 v184, 0x12000, v184
  v_add_u32 v248, 0x12000, v248
  v_mfma_f32_32x32x16_bf16 v[112:127], v[156:159], v[128:131], v[112:127]
  v_add_u32 v185, 0x12000, v185
  s_add_u32 s66, s66, s68
  s_add_u32 s97, s66, 262144
  s_lshl_b32 s66, s36, 8
  s_waitcnt lgkmcnt(0)
  v_mfma_f32_32x32x16_bf16 v[16:31], v[160:163], v[132:135], v[16:31]
  s_add_u32 s66, s66, 114688
  v_lshlrev_b32 v206, 2, v1
  v_add_u32 v207, s66, v206
  v_lshl_add_u32 v208, v11, 4, s66
  v_mfma_f32_32x32x16_bf16 v[32:47], v[160:163], v[140:143], v[32:47]
  s_waitcnt vmcnt(15)
  s_barrier
  ds_read_b128 v[128:131], v176
  ds_read_b64_tr_b16 v[144:145], v184 offset:0
  s_lshl_b32 s66, s37, 13
  v_mfma_f32_32x32x16_bf16 v[48:63], v[164:167], v[132:135], v[48:63]
  ds_read_b64_tr_b16 v[146:147], v184 offset:1792
  ds_read_b128 v[136:139], v180
  s_lshl_b32 s67, s38, 11
  s_add_u32 s66, s66, s67
  v_mfma_f32_32x32x16_bf16 v[64:79], v[164:167], v[140:143], v[64:79]
  ds_read_b64_tr_b16 v[148:149], v184 offset:64
  ds_read_b64_tr_b16 v[150:151], v184 offset:1856
  v_add_u32 v210, s66, v2
  v_and_b32 v9, 1, v4
  v_mfma_f32_32x32x16_bf16 v[80:95], v[168:171], v[132:135], v[80:95]
  ds_read_b64_tr_b16 v[152:153], v248 offset:0
  ds_read_b64_tr_b16 v[154:155], v248 offset:1792
  v_lshl_add_u32 v9, v9, 2, v5
  v_lshlrev_b32 v13, 3, v6
  v_mfma_f32_32x32x16_bf16 v[96:111], v[168:171], v[140:143], v[96:111]
  ds_read_b64_tr_b16 v[156:157], v185 offset:0
  ds_read_b64_tr_b16 v[158:159], v185 offset:1792
  v_lshl_add_u32 v211, v9, 10, v13
  v_mfma_f32_32x32x16_bf16 v[112:127], v[172:175], v[132:135], v[112:127]
  s_waitcnt lgkmcnt(4)
  v_mfma_f32_32x32x16_bf16 v[16:31], v[144:147], v[128:131], v[16:31]
  ds_read_b128 v[132:135], v177
  ds_read_b64_tr_b16 v[160:161], v184 offset:7168
  v_add_u32 v176, 0xb000, v176
  v_mfma_f32_32x32x16_bf16 v[32:47], v[144:147], v[136:139], v[32:47]
  s_add_u32 m0, s45, 0
  ds_read_b64_tr_b16 v[162:163], v184 offset:8960
  ds_read_b128 v[140:143], v181
  buffer_load_dwordx4 v186, s[4:7], s43 offen offset:0 lds
  v_mfma_f32_32x32x16_bf16 v[48:63], v[148:151], v[128:131], v[48:63]
  ds_read_b64_tr_b16 v[164:165], v184 offset:7232
  ds_read_b64_tr_b16 v[166:167], v184 offset:9024
  v_add_u32 v180, 0xb000, v180
  v_mfma_f32_32x32x16_bf16 v[64:79], v[148:151], v[136:139], v[64:79]
  ds_read_b64_tr_b16 v[168:169], v248 offset:7168
  ds_read_b64_tr_b16 v[170:171], v248 offset:8960
  buffer_load_dwordx4 v187, s[4:7], s43 offen offset:1024 lds
  s_cmp_eq_u32 s47, 2
  s_cselect_b32 s49, -7, 1
  s_waitcnt lgkmcnt(8)
  v_mfma_f32_32x32x16_bf16 v[80:95], v[152:155], v[128:131], v[80:95]
  ds_read_b64_tr_b16 v[172:173], v185 offset:7168
  ds_read_b64_tr_b16 v[174:175], v185 offset:8960
  v_add_u32 v177, 0xb000, v177
  v_add_u32 v181, 0xb000, v181
  v_mfma_f32_32x32x16_bf16 v[96:111], v[152:155], v[136:139], v[96:111]
  buffer_load_dwordx4 v188, s[4:7], s43 offen offset:2048 lds
  s_lshl_b32 s87, s49, 7
  v_mfma_f32_32x32x16_bf16 v[112:127], v[156:159], v[128:131], v[112:127]
  buffer_load_dwordx4 v189, s[4:7], s43 offen offset:3072 lds
  s_add_u32 s43, s43, s87
  s_waitcnt lgkmcnt(4)
  v_mfma_f32_32x32x16_bf16 v[16:31], v[160:163], v[132:135], v[16:31]
  ds_read_b128 v[128:131], v178
  ds_read_b64_tr_b16 v[144:145], v184 offset:14336
  v_mfma_f32_32x32x16_bf16 v[32:47], v[160:163], v[140:143], v[32:47]
  s_add_u32 m0, s46, 16384
  ds_read_b64_tr_b16 v[146:147], v184 offset:16128
  ds_read_b128 v[136:139], v182
  buffer_load_dwordx4 v190, s[12:15], s44 offen offset:0 lds
  v_mfma_f32_32x32x16_bf16 v[48:63], v[164:167], v[132:135], v[48:63]
  ds_read_b64_tr_b16 v[148:149], v184 offset:14400
  ds_read_b64_tr_b16 v[150:151], v184 offset:16192
  v_mfma_f32_32x32x16_bf16 v[64:79], v[164:167], v[140:143], v[64:79]
  ds_read_b64_tr_b16 v[152:153], v248 offset:14336
  ds_read_b64_tr_b16 v[154:155], v248 offset:16128
  buffer_load_dwordx4 v191, s[12:15], s44 offen offset:1024 lds
  s_mul_i32 s49, s49, 229376
  s_waitcnt lgkmcnt(8)
  v_mfma_f32_32x32x16_bf16 v[80:95], v[168:171], v[132:135], v[80:95]
  ds_read_b64_tr_b16 v[156:157], v185 offset:14336
  ds_read_b64_tr_b16 v[158:159], v185 offset:16128
  v_add_u32 v178, 0xb000, v178
  v_add_u32 v182, 0xb000, v182
  v_mfma_f32_32x32x16_bf16 v[96:111], v[168:171], v[140:143], v[96:111]
  buffer_load_dwordx4 v192, s[12:15], s44 offen offset:2048 lds
  v_mfma_f32_32x32x16_bf16 v[112:127], v[172:175], v[132:135], v[112:127]
  buffer_load_dwordx4 v193, s[12:15], s44 offen offset:3072 lds
  s_waitcnt lgkmcnt(4)
  v_mfma_f32_32x32x16_bf16 v[16:31], v[144:147], v[128:131], v[16:31]
  ds_read_b128 v[132:135], v179
  ds_read_b64_tr_b16 v[160:161], v184 offset:21504
  v_mfma_f32_32x32x16_bf16 v[32:47], v[144:147], v[136:139], v[32:47]
  s_add_u32 m0, s46, 20480
  ds_read_b64_tr_b16 v[162:163], v184 offset:23296
  ds_read_b128 v[140:143], v183
  buffer_load_dwordx4 v194, s[12:15], s44 offen offset:0 lds
  v_mfma_f32_32x32x16_bf16 v[48:63], v[148:151], v[128:131], v[48:63]
  ds_read_b64_tr_b16 v[164:165], v184 offset:21568
  ds_read_b64_tr_b16 v[166:167], v184 offset:23360
  v_mfma_f32_32x32x16_bf16 v[64:79], v[148:151], v[136:139], v[64:79]
  ds_read_b64_tr_b16 v[168:169], v248 offset:21504
  ds_read_b64_tr_b16 v[170:171], v248 offset:23296
  buffer_load_dwordx4 v195, s[12:15], s44 offen offset:1024 lds
  s_waitcnt lgkmcnt(8)
  v_mfma_f32_32x32x16_bf16 v[80:95], v[152:155], v[128:131], v[80:95]
  ds_read_b64_tr_b16 v[172:173], v185 offset:21504
  ds_read_b64_tr_b16 v[174:175], v185 offset:23296
  v_add_u32 v179, 0xb000, v179
  v_add_u32 v183, 0xb000, v183
  v_mfma_f32_32x32x16_bf16 v[96:111], v[152:155], v[136:139], v[96:111]
  buffer_load_dwordx4 v196, s[12:15], s44 offen offset:2048 lds
  s_add_u32 s44, s44, s49
  v_add_u32 v184, 0xb000, v184
  v_add_u32 v248, 0xb000, v248
  v_mfma_f32_32x32x16_bf16 v[112:127], v[156:159], v[128:131], v[112:127]
  v_add_u32 v185, 0xb000, v185
  s_waitcnt lgkmcnt(0)
  v_mfma_f32_32x32x16_bf16 v[16:31], v[160:163], v[132:135], v[16:31]
  v_mfma_f32_32x32x16_bf16 v[32:47], v[160:163], v[140:143], v[32:47]
  s_waitcnt vmcnt(11)
  s_barrier
  ds_read_b128 v[128:131], v176
  ds_read_b64_tr_b16 v[144:145], v184 offset:0
  v_mfma_f32_32x32x16_bf16 v[48:63], v[164:167], v[132:135], v[48:63]
  ds_read_b64_tr_b16 v[146:147], v184 offset:1792
  ds_read_b128 v[136:139], v180
  v_mfma_f32_32x32x16_bf16 v[64:79], v[164:167], v[140:143], v[64:79]
  ds_read_b64_tr_b16 v[148:149], v184 offset:64
  ds_read_b64_tr_b16 v[150:151], v184 offset:1856
  v_mfma_f32_32x32x16_bf16 v[80:95], v[168:171], v[132:135], v[80:95]
  ds_read_b64_tr_b16 v[152:153], v248 offset:0
  ds_read_b64_tr_b16 v[154:155], v248 offset:1792
  v_mfma_f32_32x32x16_bf16 v[96:111], v[168:171], v[140:143], v[96:111]
  ds_read_b64_tr_b16 v[156:157], v185 offset:0
  ds_read_b64_tr_b16 v[158:159], v185 offset:1792
  v_mfma_f32_32x32x16_bf16 v[112:127], v[172:175], v[132:135], v[112:127]
  s_waitcnt lgkmcnt(4)
  v_mfma_f32_32x32x16_bf16 v[16:31], v[144:147], v[128:131], v[16:31]
  ds_read_b128 v[132:135], v177
  ds_read_b64_tr_b16 v[160:161], v184 offset:7168
  v_add_u32 v176, 0xfffe3000, v176
  v_mfma_f32_32x32x16_bf16 v[32:47], v[144:147], v[136:139], v[32:47]
  s_add_u32 m0, s45, 73728
  ds_read_b64_tr_b16 v[162:163], v184 offset:8960
  ds_read_b128 v[140:143], v181
  buffer_load_dwordx4 v186, s[4:7], s43 offen offset:0 lds
  v_mfma_f32_32x32x16_bf16 v[48:63], v[148:151], v[128:131], v[48:63]
  ds_read_b64_tr_b16 v[164:165], v184 offset:7232
  ds_read_b64_tr_b16 v[166:167], v184 offset:9024
  v_add_u32 v180, 0xfffe3000, v180
  v_mfma_f32_32x32x16_bf16 v[64:79], v[148:151], v[136:139], v[64:79]
  ds_read_b64_tr_b16 v[168:169], v248 offset:7168
  ds_read_b64_tr_b16 v[170:171], v248 offset:8960
  buffer_load_dwordx4 v187, s[4:7], s43 offen offset:1024 lds
  s_cmp_eq_u32 s47, 1
  s_cselect_b32 s49, -7, 1
  s_waitcnt lgkmcnt(8)
  v_mfma_f32_32x32x16_bf16 v[80:95], v[152:155], v[128:131], v[80:95]
  ds_read_b64_tr_b16 v[172:173], v185 offset:7168
  ds_read_b64_tr_b16 v[174:175], v185 offset:8960
  v_add_u32 v177, 0xfffe3000, v177
  v_add_u32 v181, 0xfffe3000, v181
  v_mfma_f32_32x32x16_bf16 v[96:111], v[152:155], v[136:139], v[96:111]
  buffer_load_dwordx4 v188, s[4:7], s43 offen offset:2048 lds
  s_lshl_b32 s87, s49, 7
  v_mfma_f32_32x32x16_bf16 v[112:127], v[156:159], v[128:131], v[112:127]
  buffer_load_dwordx4 v189, s[4:7], s43 offen offset:3072 lds
  s_add_u32 s43, s43, s87
  s_waitcnt lgkmcnt(4)
  v_mfma_f32_32x32x16_bf16 v[16:31], v[160:163], v[132:135], v[16:31]
  ds_read_b128 v[128:131], v178
  ds_read_b64_tr_b16 v[144:145], v184 offset:14336
  v_mfma_f32_32x32x16_bf16 v[32:47], v[160:163], v[140:143], v[32:47]
  s_add_u32 m0, s46, 90112
  ds_read_b64_tr_b16 v[146:147], v184 offset:16128
  ds_read_b128 v[136:139], v182
  buffer_load_dwordx4 v190, s[12:15], s44 offen offset:0 lds
  v_mfma_f32_32x32x16_bf16 v[48:63], v[164:167], v[132:135], v[48:63]
  ds_read_b64_tr_b16 v[148:149], v184 offset:14400
  ds_read_b64_tr_b16 v[150:151], v184 offset:16192
  v_mfma_f32_32x32x16_bf16 v[64:79], v[164:167], v[140:143], v[64:79]
  ds_read_b64_tr_b16 v[152:153], v248 offset:14336
  ds_read_b64_tr_b16 v[154:155], v248 offset:16128
  buffer_load_dwordx4 v191, s[12:15], s44 offen offset:1024 lds
  s_mul_i32 s49, s49, 229376
  s_waitcnt lgkmcnt(8)
  v_mfma_f32_32x32x16_bf16 v[80:95], v[168:171], v[132:135], v[80:95]
  ds_read_b64_tr_b16 v[156:157], v185 offset:14336
  ds_read_b64_tr_b16 v[158:159], v185 offset:16128
  v_add_u32 v178, 0xfffe3000, v178
  v_add_u32 v182, 0xfffe3000, v182
  v_mfma_f32_32x32x16_bf16 v[96:111], v[168:171], v[140:143], v[96:111]
  buffer_load_dwordx4 v192, s[12:15], s44 offen offset:2048 lds
  v_mfma_f32_32x32x16_bf16 v[112:127], v[172:175], v[132:135], v[112:127]
  buffer_load_dwordx4 v193, s[12:15], s44 offen offset:3072 lds
  s_waitcnt lgkmcnt(4)
  v_mfma_f32_32x32x16_bf16 v[16:31], v[144:147], v[128:131], v[16:31]
  ds_read_b128 v[132:135], v179
  ds_read_b64_tr_b16 v[160:161], v184 offset:21504
  v_mfma_f32_32x32x16_bf16 v[32:47], v[144:147], v[136:139], v[32:47]
  s_add_u32 m0, s46, 94208
  ds_read_b64_tr_b16 v[162:163], v184 offset:23296
  ds_read_b128 v[140:143], v183
  buffer_load_dwordx4 v194, s[12:15], s44 offen offset:0 lds
  v_mfma_f32_32x32x16_bf16 v[48:63], v[148:151], v[128:131], v[48:63]
  ds_read_b64_tr_b16 v[164:165], v184 offset:21568
  ds_read_b64_tr_b16 v[166:167], v184 offset:23360
  v_mfma_f32_32x32x16_bf16 v[64:79], v[148:151], v[136:139], v[64:79]
  ds_read_b64_tr_b16 v[168:169], v248 offset:21504
  ds_read_b64_tr_b16 v[170:171], v248 offset:23296
  buffer_load_dwordx4 v195, s[12:15], s44 offen offset:1024 lds
  s_waitcnt lgkmcnt(8)
  v_mfma_f32_32x32x16_bf16 v[80:95], v[152:155], v[128:131], v[80:95]
  ds_read_b64_tr_b16 v[172:173], v185 offset:21504
  ds_read_b64_tr_b16 v[174:175], v185 offset:23296
  v_add_u32 v179, 0xfffe3000, v179
  v_add_u32 v183, 0xfffe3000, v183
  v_mfma_f32_32x32x16_bf16 v[96:111], v[152:155], v[136:139], v[96:111]
  buffer_load_dwordx4 v196, s[12:15], s44 offen offset:2048 lds
  s_add_u32 s44, s44, s49
  v_add_u32 v184, 0xfffe3000, v184
  v_add_u32 v248, 0xfffe3000, v248
  v_mfma_f32_32x32x16_bf16 v[112:127], v[156:159], v[128:131], v[112:127]
  v_add_u32 v185, 0xfffe3000, v185
  s_waitcnt lgkmcnt(0)
  v_mfma_f32_32x32x16_bf16 v[16:31], v[160:163], v[132:135], v[16:31]
  v_mfma_f32_32x32x16_bf16 v[32:47], v[160:163], v[140:143], v[32:47]
  s_waitcnt vmcnt(11)
  s_barrier
  ds_read_b128 v[128:131], v176
  ds_read_b64_tr_b16 v[144:145], v184 offset:0
  v_mfma_f32_32x32x16_bf16 v[48:63], v[164:167], v[132:135], v[48:63]
  ds_read_b64_tr_b16 v[146:147], v184 offset:1792
  ds_read_b128 v[136:139], v180
  v_mfma_f32_32x32x16_bf16 v[64:79], v[164:167], v[140:143], v[64:79]
  ds_read_b64_tr_b16 v[148:149], v184 offset:64
  ds_read_b64_tr_b16 v[150:151], v184 offset:1856
  v_mfma_f32_32x32x16_bf16 v[80:95], v[168:171], v[132:135], v[80:95]
  ds_read_b64_tr_b16 v[152:153], v248 offset:0
  ds_read_b64_tr_b16 v[154:155], v248 offset:1792
  v_mfma_f32_32x32x16_bf16 v[96:111], v[168:171], v[140:143], v[96:111]
  ds_read_b64_tr_b16 v[156:157], v185 offset:0
  ds_read_b64_tr_b16 v[158:159], v185 offset:1792
  v_mfma_f32_32x32x16_bf16 v[112:127], v[172:175], v[132:135], v[112:127]
  s_waitcnt lgkmcnt(4)
  v_mfma_f32_32x32x16_bf16 v[16:31], v[144:147], v[128:131], v[16:31]
  ds_read_b128 v[132:135], v177
  ds_read_b64_tr_b16 v[160:161], v184 offset:7168
  v_add_u32 v176, 0x12000, v176
  v_mfma_f32_32x32x16_bf16 v[32:47], v[144:147], v[136:139], v[32:47]
  s_add_u32 m0, s45, 118784
  ds_read_b64_tr_b16 v[162:163], v184 offset:8960
  ds_read_b128 v[140:143], v181
  buffer_load_dwordx4 v186, s[4:7], s43 offen offset:0 lds
  v_mfma_f32_32x32x16_bf16 v[48:63], v[148:151], v[128:131], v[48:63]
  ds_read_b64_tr_b16 v[164:165], v184 offset:7232
  ds_read_b64_tr_b16 v[166:167], v184 offset:9024
  v_add_u32 v180, 0x12000, v180
  v_mfma_f32_32x32x16_bf16 v[64:79], v[148:151], v[136:139], v[64:79]
  ds_read_b64_tr_b16 v[168:169], v248 offset:7168
  ds_read_b64_tr_b16 v[170:171], v248 offset:8960
  buffer_load_dwordx4 v187, s[4:7], s43 offen offset:1024 lds
  s_cmp_eq_u32 s47, 0
  s_cselect_b32 s49, -7, 1
  s_waitcnt lgkmcnt(8)
  v_mfma_f32_32x32x16_bf16 v[80:95], v[152:155], v[128:131], v[80:95]
  ds_read_b64_tr_b16 v[172:173], v185 offset:7168
  ds_read_b64_tr_b16 v[174:175], v185 offset:8960
  v_add_u32 v177, 0x12000, v177
  v_add_u32 v181, 0x12000, v181
  v_mfma_f32_32x32x16_bf16 v[96:111], v[152:155], v[136:139], v[96:111]
  buffer_load_dwordx4 v188, s[4:7], s43 offen offset:2048 lds
  s_lshl_b32 s87, s49, 7
  v_mfma_f32_32x32x16_bf16 v[112:127], v[156:159], v[128:131], v[112:127]
  buffer_load_dwordx4 v189, s[4:7], s43 offen offset:3072 lds
  s_add_u32 s43, s43, s87
  s_waitcnt lgkmcnt(4)
  v_mfma_f32_32x32x16_bf16 v[16:31], v[160:163], v[132:135], v[16:31]
  ds_read_b128 v[128:131], v178
  ds_read_b64_tr_b16 v[144:145], v184 offset:14336
  v_mfma_f32_32x32x16_bf16 v[32:47], v[160:163], v[140:143], v[32:47]
  s_add_u32 m0, s46, 135168
  ds_read_b64_tr_b16 v[146:147], v184 offset:16128
  ds_read_b128 v[136:139], v182
  buffer_load_dwordx4 v190, s[12:15], s44 offen offset:0 lds
  v_mfma_f32_32x32x16_bf16 v[48:63], v[164:167], v[132:135], v[48:63]
  ds_read_b64_tr_b16 v[148:149], v184 offset:14400
  ds_read_b64_tr_b16 v[150:151], v184 offset:16192
  v_mfma_f32_32x32x16_bf16 v[64:79], v[164:167], v[140:143], v[64:79]
  ds_read_b64_tr_b16 v[152:153], v248 offset:14336
  ds_read_b64_tr_b16 v[154:155], v248 offset:16128
  buffer_load_dwordx4 v191, s[12:15], s44 offen offset:1024 lds
  s_mul_i32 s49, s49, 229376
  s_waitcnt lgkmcnt(8)
  v_mfma_f32_32x32x16_bf16 v[80:95], v[168:171], v[132:135], v[80:95]
  ds_read_b64_tr_b16 v[156:157], v185 offset:14336
  ds_read_b64_tr_b16 v[158:159], v185 offset:16128
  v_add_u32 v178, 0x12000, v178
  v_add_u32 v182, 0x12000, v182
  v_mfma_f32_32x32x16_bf16 v[96:111], v[168:171], v[140:143], v[96:111]
  buffer_load_dwordx4 v192, s[12:15], s44 offen offset:2048 lds
  v_mfma_f32_32x32x16_bf16 v[112:127], v[172:175], v[132:135], v[112:127]
  buffer_load_dwordx4 v193, s[12:15], s44 offen offset:3072 lds
  s_waitcnt lgkmcnt(4)
  v_mfma_f32_32x32x16_bf16 v[16:31], v[144:147], v[128:131], v[16:31]
  ds_read_b128 v[132:135], v179
  ds_read_b64_tr_b16 v[160:161], v184 offset:21504
  v_mfma_f32_32x32x16_bf16 v[32:47], v[144:147], v[136:139], v[32:47]
  s_add_u32 m0, s46, 139264
  ds_read_b64_tr_b16 v[162:163], v184 offset:23296
  ds_read_b128 v[140:143], v183
  buffer_load_dwordx4 v194, s[12:15], s44 offen offset:0 lds
  v_mfma_f32_32x32x16_bf16 v[48:63], v[148:151], v[128:131], v[48:63]
  ds_read_b64_tr_b16 v[164:165], v184 offset:21568
  ds_read_b64_tr_b16 v[166:167], v184 offset:23360
  v_mfma_f32_32x32x16_bf16 v[64:79], v[148:151], v[136:139], v[64:79]
  ds_read_b64_tr_b16 v[168:169], v248 offset:21504
  ds_read_b64_tr_b16 v[170:171], v248 offset:23296
  buffer_load_dwordx4 v195, s[12:15], s44 offen offset:1024 lds
  s_waitcnt lgkmcnt(8)
  v_mfma_f32_32x32x16_bf16 v[80:95], v[152:155], v[128:131], v[80:95]
  ds_read_b64_tr_b16 v[172:173], v185 offset:21504
  ds_read_b64_tr_b16 v[174:175], v185 offset:23296
  v_add_u32 v179, 0x12000, v179
  v_add_u32 v183, 0x12000, v183
  v_mfma_f32_32x32x16_bf16 v[96:111], v[152:155], v[136:139], v[96:111]
  buffer_load_dwordx4 v196, s[12:15], s44 offen offset:2048 lds
  s_add_u32 s44, s44, s49
  v_add_u32 v184, 0x12000, v184
  v_add_u32 v248, 0x12000, v248
  v_mfma_f32_32x32x16_bf16 v[112:127], v[156:159], v[128:131], v[112:127]
  v_add_u32 v185, 0x12000, v185
  s_waitcnt lgkmcnt(0)
  v_mfma_f32_32x32x16_bf16 v[16:31], v[160:163], v[132:135], v[16:31]
  v_mfma_f32_32x32x16_bf16 v[32:47], v[160:163], v[140:143], v[32:47]
  s_waitcnt vmcnt(11)
  s_barrier
  ds_read_b128 v[128:131], v176
  ds_read_b64_tr_b16 v[144:145], v184 offset:0
  v_mfma_f32_32x32x16_bf16 v[48:63], v[164:167], v[132:135], v[48:63]
  ds_read_b64_tr_b16 v[146:147], v184 offset:1792
  ds_read_b128 v[136:139], v180
  v_mfma_f32_32x32x16_bf16 v[64:79], v[164:167], v[140:143], v[64:79]
  ds_read_b64_tr_b16 v[148:149], v184 offset:64
  ds_read_b64_tr_b16 v[150:151], v184 offset:1856
  v_mfma_f32_32x32x16_bf16 v[80:95], v[168:171], v[132:135], v[80:95]
  ds_read_b64_tr_b16 v[152:153], v248 offset:0
  ds_read_b64_tr_b16 v[154:155], v248 offset:1792
  v_mfma_f32_32x32x16_bf16 v[96:111], v[168:171], v[140:143], v[96:111]
  ds_read_b64_tr_b16 v[156:157], v185 offset:0
  ds_read_b64_tr_b16 v[158:159], v185 offset:1792
  v_mfma_f32_32x32x16_bf16 v[112:127], v[172:175], v[132:135], v[112:127]
  s_waitcnt lgkmcnt(4)
  v_mfma_f32_32x32x16_bf16 v[16:31], v[144:147], v[128:131], v[16:31]
  ds_read_b128 v[132:135], v177
  ds_read_b64_tr_b16 v[160:161], v184 offset:7168
  v_add_u32 v176, 0xb000, v176
  buffer_load_dword v205, v3, s[20:23], 0 offen sc1
  v_mfma_f32_32x32x16_bf16 v[32:47], v[144:147], v[136:139], v[32:47]
  ds_read_b64_tr_b16 v[162:163], v184 offset:8960
  ds_read_b128 v[140:143], v181
  v_mfma_f32_32x32x16_bf16 v[48:63], v[148:151], v[128:131], v[48:63]
  ds_read_b64_tr_b16 v[164:165], v184 offset:7232
  ds_read_b64_tr_b16 v[166:167], v184 offset:9024
  v_add_u32 v180, 0xb000, v180
  v_mfma_f32_32x32x16_bf16 v[64:79], v[148:151], v[136:139], v[64:79]
  s_add_u32 m0, s52, 0
  ds_read_b64_tr_b16 v[168:169], v248 offset:7168
  ds_read_b64_tr_b16 v[170:171], v248 offset:8960
  s_bfe_u32 s69, s48, 0x80000
  s_lshl_b32 s69, s69, 14
  s_add_u32 s51, s69, s100
  buffer_load_dwordx4 v197, s[24:27], s51 offen lds
  s_waitcnt lgkmcnt(8)
  v_mfma_f32_32x32x16_bf16 v[80:95], v[152:155], v[128:131], v[80:95]
  ds_read_b64_tr_b16 v[172:173], v185 offset:7168
  ds_read_b64_tr_b16 v[174:175], v185 offset:8960
  v_add_u32 v177, 0xb000, v177
  v_add_u32 v181, 0xb000, v181
  v_mfma_f32_32x32x16_bf16 v[96:111], v[152:155], v[136:139], v[96:111]
  buffer_load_dwordx4 v198, s[24:27], s51 offen offset:1024 lds
  s_add_u32 s51, s51, 16384
  v_mfma_f32_32x32x16_bf16 v[112:127], v[156:159], v[128:131], v[112:127]
  s_add_u32 m0, s52, 2048
  s_nop 0
  buffer_load_dwordx4 v197, s[24:27], s51 offen lds
  s_waitcnt lgkmcnt(4)
  v_mfma_f32_32x32x16_bf16 v[16:31], v[160:163], v[132:135], v[16:31]
  ds_read_b128 v[128:131], v178
  ds_read_b64_tr_b16 v[144:145], v184 offset:14336
  v_mfma_f32_32x32x16_bf16 v[32:47], v[160:163], v[140:143], v[32:47]
  ds_read_b64_tr_b16 v[146:147], v184 offset:16128
  ds_read_b128 v[136:139], v182
  buffer_load_dwordx4 v198, s[24:27], s51 offen offset:1024 lds
  s_add_u32 s51, s51, 16384
  v_mfma_f32_32x32x16_bf16 v[48:63], v[164:167], v[132:135], v[48:63]
  ds_read_b64_tr_b16 v[148:149], v184 offset:14400
  ds_read_b64_tr_b16 v[150:151], v184 offset:16192
  v_mfma_f32_32x32x16_bf16 v[64:79], v[164:167], v[140:143], v[64:79]
  s_add_u32 m0, s52, 4096
  ds_read_b64_tr_b16 v[152:153], v248 offset:14336
  ds_read_b64_tr_b16 v[154:155], v248 offset:16128
  buffer_load_dwordx4 v197, s[24:27], s51 offen lds
  s_waitcnt lgkmcnt(8)
  v_mfma_f32_32x32x16_bf16 v[80:95], v[168:171], v[132:135], v[80:95]
  ds_read_b64_tr_b16 v[156:157], v185 offset:14336
  ds_read_b64_tr_b16 v[158:159], v185 offset:16128
  v_add_u32 v178, 0xb000, v178
  v_add_u32 v182, 0xb000, v182
  v_mfma_f32_32x32x16_bf16 v[96:111], v[168:171], v[140:143], v[96:111]
  buffer_load_dwordx4 v198, s[24:27], s51 offen offset:1024 lds
  s_add_u32 s51, s51, 16384
  v_mfma_f32_32x32x16_bf16 v[112:127], v[172:175], v[132:135], v[112:127]
  s_add_u32 m0, s52, 6144
  s_nop 0
  buffer_load_dwordx4 v197, s[24:27], s51 offen lds
  s_waitcnt lgkmcnt(4)
  v_mfma_f32_32x32x16_bf16 v[16:31], v[144:147], v[128:131], v[16:31]
  ds_read_b128 v[132:135], v179
  ds_read_b64_tr_b16 v[160:161], v184 offset:21504
  v_mfma_f32_32x32x16_bf16 v[32:47], v[144:147], v[136:139], v[32:47]
  ds_read_b64_tr_b16 v[162:163], v184 offset:23296
  ds_read_b128 v[140:143], v183
  v_mfma_f32_32x32x16_bf16 v[48:63], v[148:151], v[128:131], v[48:63]
  ds_read_b64_tr_b16 v[164:165], v184 offset:21568
  ds_read_b64_tr_b16 v[166:167], v184 offset:23360
  v_mfma_f32_32x32x16_bf16 v[64:79], v[148:151], v[136:139], v[64:79]
  ds_read_b64_tr_b16 v[168:169], v248 offset:21504
  ds_read_b64_tr_b16 v[170:171], v248 offset:23296
  buffer_load_dwordx4 v198, s[24:27], s51 offen offset:1024 lds
  s_add_u32 s51, s51, 16384
  s_waitcnt lgkmcnt(8)
  v_mfma_f32_32x32x16_bf16 v[80:95], v[152:155], v[128:131], v[80:95]
  ds_read_b64_tr_b16 v[172:173], v185 offset:21504
  ds_read_b64_tr_b16 v[174:175], v185 offset:23296
  v_add_u32 v179, 0xb000, v179
  v_add_u32 v183, 0xb000, v183
  v_mfma_f32_32x32x16_bf16 v[96:111], v[152:155], v[136:139], v[96:111]
  s_add_u32 m0, s52, 8192
  s_bfe_u32 s69, s0, 0x80000
  s_lshl_b32 s69, s69, 14
  s_add_u32 s51, s69, s100
  buffer_load_dwordx4 v197, s[24:27], s51 offen lds
  v_add_u32 v184, 0xb000, v184
  v_add_u32 v248, 0xb000, v248
  v_mfma_f32_32x32x16_bf16 v[112:127], v[156:159], v[128:131], v[112:127]
  buffer_load_dwordx4 v198, s[24:27], s51 offen offset:1024 lds
  s_add_u32 s51, s51, 16384
  v_add_u32 v185, 0xb000, v185
  s_waitcnt lgkmcnt(0)
  v_mfma_f32_32x32x16_bf16 v[16:31], v[160:163], v[132:135], v[16:31]
  v_mfma_f32_32x32x16_bf16 v[32:47], v[160:163], v[140:143], v[32:47]
  s_waitcnt vmcnt(11)
  s_barrier
  ds_read_b128 v[128:131], v176
  ds_read_b64_tr_b16 v[144:145], v184 offset:0
  v_mfma_f32_32x32x16_bf16 v[48:63], v[164:167], v[132:135], v[48:63]
  s_add_u32 m0, s52, 10240
  ds_read_b64_tr_b16 v[146:147], v184 offset:1792
  ds_read_b128 v[136:139], v180
  buffer_load_dwordx4 v197, s[24:27], s51 offen lds
  v_mfma_f32_32x32x16_bf16 v[64:79], v[164:167], v[140:143], v[64:79]
  ds_read_b64_tr_b16 v[148:149], v184 offset:64
  ds_read_b64_tr_b16 v[150:151], v184 offset:1856
  buffer_load_dwordx4 v198, s[24:27], s51 offen offset:1024 lds
  s_add_u32 s51, s51, 16384
  v_mfma_f32_32x32x16_bf16 v[80:95], v[168:171], v[132:135], v[80:95]
  s_add_u32 m0, s52, 12288
  ds_read_b64_tr_b16 v[152:153], v248 offset:0
  ds_read_b64_tr_b16 v[154:155], v248 offset:1792
  buffer_load_dwordx4 v197, s[24:27], s51 offen lds
  v_mfma_f32_32x32x16_bf16 v[96:111], v[168:171], v[140:143], v[96:111]
  ds_read_b64_tr_b16 v[156:157], v185 offset:0
  ds_read_b64_tr_b16 v[158:159], v185 offset:1792
  buffer_load_dwordx4 v198, s[24:27], s51 offen offset:1024 lds
  s_add_u32 s51, s51, 16384
  v_mfma_f32_32x32x16_bf16 v[112:127], v[172:175], v[132:135], v[112:127]
  s_waitcnt lgkmcnt(4)
  v_mfma_f32_32x32x16_bf16 v[16:31], v[144:147], v[128:131], v[16:31]
  ds_read_b128 v[132:135], v177
  ds_read_b64_tr_b16 v[160:161], v184 offset:7168
  v_mfma_f32_32x32x16_bf16 v[32:47], v[144:147], v[136:139], v[32:47]
  ds_read_b64_tr_b16 v[162:163], v184 offset:8960
  ds_read_b128 v[140:143], v181
  v_mfma_f32_32x32x16_bf16 v[48:63], v[148:151], v[128:131], v[48:63]
  ds_read_b64_tr_b16 v[164:165], v184 offset:7232
  ds_read_b64_tr_b16 v[166:167], v184 offset:9024
  v_mfma_f32_32x32x16_bf16 v[64:79], v[148:151], v[136:139], v[64:79]
  s_add_u32 m0, s52, 14336
  ds_read_b64_tr_b16 v[168:169], v248 offset:7168
  ds_read_b64_tr_b16 v[170:171], v248 offset:8960
  s_bfe_u32 s69, s1, 0x80000
  s_lshl_b32 s69, s69, 14
  s_add_u32 s51, s69, s54
  buffer_load_dwordx4 v197, s[8:11], s51 offen lds
  s_waitcnt lgkmcnt(8)
  v_mfma_f32_32x32x16_bf16 v[80:95], v[152:155], v[128:131], v[80:95]
  ds_read_b64_tr_b16 v[172:173], v185 offset:7168
  ds_read_b64_tr_b16 v[174:175], v185 offset:8960
  v_mfma_f32_32x32x16_bf16 v[96:111], v[152:155], v[136:139], v[96:111]
  buffer_load_dwordx4 v198, s[8:11], s51 offen offset:1024 lds
  s_add_u32 s51, s51, 16384
  v_mfma_f32_32x32x16_bf16 v[112:127], v[156:159], v[128:131], v[112:127]
  s_waitcnt lgkmcnt(4)
  v_mfma_f32_32x32x16_bf16 v[16:31], v[160:163], v[132:135], v[16:31]
  ds_read_b128 v[128:131], v178
  ds_read_b64_tr_b16 v[144:145], v184 offset:14336
  v_mfma_f32_32x32x16_bf16 v[32:47], v[160:163], v[140:143], v[32:47]
  s_add_u32 m0, s53, 0
  ds_read_b64_tr_b16 v[146:147], v184 offset:16128
  ds_read_b128 v[136:139], v182
  buffer_load_dwordx4 v197, s[8:11], s51 offen lds
  v_mfma_f32_32x32x16_bf16 v[48:63], v[164:167], v[132:135], v[48:63]
  ds_read_b64_tr_b16 v[148:149], v184 offset:14400
  ds_read_b64_tr_b16 v[150:151], v184 offset:16192
  v_mfma_f32_32x32x16_bf16 v[64:79], v[164:167], v[140:143], v[64:79]
  ds_read_b64_tr_b16 v[152:153], v248 offset:14336
  ds_read_b64_tr_b16 v[154:155], v248 offset:16128
  buffer_load_dwordx4 v198, s[8:11], s51 offen offset:1024 lds
  s_add_u32 s51, s51, 16384
  s_waitcnt lgkmcnt(8)
  v_mfma_f32_32x32x16_bf16 v[80:95], v[168:171], v[132:135], v[80:95]
  ds_read_b64_tr_b16 v[156:157], v185 offset:14336
  ds_read_b64_tr_b16 v[158:159], v185 offset:16128
  v_mfma_f32_32x32x16_bf16 v[96:111], v[168:171], v[140:143], v[96:111]
  v_mfma_f32_32x32x16_bf16 v[112:127], v[172:175], v[132:135], v[112:127]
  s_add_u32 m0, s53, 2048
  s_bfe_u32 s69, s48, 0x80008
  s_lshl_b32 s69, s69, 14
  s_add_u32 s51, s69, s100
  buffer_load_dwordx4 v197, s[24:27], s51 offen lds
  s_waitcnt lgkmcnt(4)
  v_mfma_f32_32x32x16_bf16 v[16:31], v[144:147], v[128:131], v[16:31]
  ds_read_b128 v[132:135], v179
  ds_read_b64_tr_b16 v[160:161], v184 offset:21504
  v_mfma_f32_32x32x16_bf16 v[32:47], v[144:147], v[136:139], v[32:47]
  ds_read_b64_tr_b16 v[162:163], v184 offset:23296
  ds_read_b128 v[140:143], v183
  buffer_load_dwordx4 v198, s[24:27], s51 offen offset:1024 lds
  s_add_u32 s51, s51, 16384
  v_mfma_f32_32x32x16_bf16 v[48:63], v[148:151], v[128:131], v[48:63]
  ds_read_b64_tr_b16 v[164:165], v184 offset:21568
  ds_read_b64_tr_b16 v[166:167], v184 offset:23360
  v_mfma_f32_32x32x16_bf16 v[64:79], v[148:151], v[136:139], v[64:79]
  ds_read_b64_tr_b16 v[168:169], v248 offset:21504
  ds_read_b64_tr_b16 v[170:171], v248 offset:23296
  s_waitcnt lgkmcnt(8)
  v_mfma_f32_32x32x16_bf16 v[80:95], v[152:155], v[128:131], v[80:95]
  ds_read_b64_tr_b16 v[172:173], v185 offset:21504
  ds_read_b64_tr_b16 v[174:175], v185 offset:23296
  v_mfma_f32_32x32x16_bf16 v[96:111], v[152:155], v[136:139], v[96:111]
  s_add_u32 m0, s53, 4096
  s_nop 0
  buffer_load_dwordx4 v197, s[24:27], s51 offen lds
  v_mfma_f32_32x32x16_bf16 v[112:127], v[156:159], v[128:131], v[112:127]
  buffer_load_dwordx4 v198, s[24:27], s51 offen offset:1024 lds
  s_add_u32 s51, s51, 16384
  s_waitcnt lgkmcnt(0)
  v_mfma_f32_32x32x16_bf16 v[16:31], v[160:163], v[132:135], v[16:31]
  v_mfma_f32_32x32x16_bf16 v[32:47], v[160:163], v[140:143], v[32:47]
  s_barrier
  v_mfma_f32_32x32x16_bf16 v[48:63], v[164:167], v[132:135], v[48:63]
  s_add_u32 m0, s53, 6144
  s_nop 0
  buffer_load_dwordx4 v197, s[24:27], s51 offen lds
  v_mfma_f32_32x32x16_bf16 v[64:79], v[164:167], v[140:143], v[64:79]
  buffer_load_dwordx4 v198, s[24:27], s51 offen offset:1024 lds
  s_add_u32 s51, s51, 16384
  v_mfma_f32_32x32x16_bf16 v[80:95], v[168:171], v[132:135], v[80:95]
  s_add_u32 m0, s53, 8192
  s_nop 0
  buffer_load_dwordx4 v197, s[24:27], s51 offen lds
  v_mfma_f32_32x32x16_bf16 v[96:111], v[168:171], v[140:143], v[96:111]
  buffer_load_dwordx4 v198, s[24:27], s51 offen offset:1024 lds
  s_add_u32 s51, s51, 16384
  v_mfma_f32_32x32x16_bf16 v[112:127], v[172:175], v[132:135], v[112:127]
  s_bfe_u32 s69, s48, 0x80010
  s_lshl_b32 s69, s69, 14
  s_add_u32 s51, s69, s100
  s_add_u32 m0, s53, 45056
  s_nop 0
  buffer_load_dwordx4 v197, s[24:27], s51 offen lds
  buffer_load_dwordx4 v198, s[24:27], s51 offen offset:1024 lds
  s_add_u32 s51, s51, 16384
  v_pk_mul_f32 v[216:217], v[16:17], s[56:57]
  v_pk_mul_f32 v[218:219], v[18:19], s[56:57]
  v_pk_mul_f32 v[220:221], v[20:21], s[56:57]
  v_pk_mul_f32 v[222:223], v[22:23], s[56:57]
  v_exp_f32 v216, v216
  v_exp_f32 v217, v217
  v_exp_f32 v218, v218
  v_exp_f32 v219, v219
  v_exp_f32 v220, v220
  v_exp_f32 v221, v221
  v_exp_f32 v222, v222
  v_exp_f32 v223, v223
  v_pk_add_f32 v[216:217], v[216:217], s[58:59]
  v_pk_add_f32 v[218:219], v[218:219], s[58:59]
  v_pk_add_f32 v[220:221], v[220:221], s[58:59]
  v_pk_add_f32 v[222:223], v[222:223], s[58:59]
  s_waitcnt vmcnt(26)
  ds_read_b64_tr_b16 a[0:1], v199 offset:0
  ds_read_b64_tr_b16 a[2:3], v199 offset:1024
  ds_read_b64_tr_b16 a[4:5], v200 offset:0
  ds_read_b64_tr_b16 a[6:7], v200 offset:1024
  v_rcp_f32 v216, v216
  v_rcp_f32 v217, v217
  v_rcp_f32 v218, v218
  v_rcp_f32 v219, v219
  v_rcp_f32 v220, v220
  v_rcp_f32 v221, v221
  v_rcp_f32 v222, v222
  v_rcp_f32 v223, v223
  v_pk_mul_f32 v[216:217], v[216:217], v[16:17]
  v_pk_mul_f32 v[218:219], v[218:219], v[18:19]
  v_pk_mul_f32 v[220:221], v[220:221], v[20:21]
  v_pk_mul_f32 v[222:223], v[222:223], v[22:23]
  v_cvt_pk_bf16_f32 v232, v216, v217
  v_cvt_pk_bf16_f32 v233, v218, v219
  v_cvt_pk_bf16_f32 v234, v220, v221
  v_cvt_pk_bf16_f32 v235, v222, v223
  s_add_u32 m0, s53, 47104
  s_nop 0
  buffer_load_dwordx4 v197, s[24:27], s51 offen lds
  buffer_load_dwordx4 v198, s[24:27], s51 offen offset:1024 lds
  s_add_u32 s51, s51, 16384
  v_pk_mul_f32 v[224:225], v[24:25], s[56:57]
  v_pk_mul_f32 v[226:227], v[26:27], s[56:57]
  v_pk_mul_f32 v[228:229], v[28:29], s[56:57]
  v_pk_mul_f32 v[230:231], v[30:31], s[56:57]
  v_exp_f32 v224, v224
  v_exp_f32 v225, v225
  v_exp_f32 v226, v226
  v_exp_f32 v227, v227
  v_exp_f32 v228, v228
  v_exp_f32 v229, v229
  v_exp_f32 v230, v230
  v_exp_f32 v231, v231
  v_pk_add_f32 v[224:225], v[224:225], s[58:59]
  v_pk_add_f32 v[226:227], v[226:227], s[58:59]
  v_pk_add_f32 v[228:229], v[228:229], s[58:59]
  v_pk_add_f32 v[230:231], v[230:231], s[58:59]
  s_waitcnt vmcnt(26)
  ds_read_b64_tr_b16 a[8:9], v199 offset:2048
  ds_read_b64_tr_b16 a[10:11], v199 offset:3072
  ds_read_b64_tr_b16 a[12:13], v200 offset:2048
  ds_read_b64_tr_b16 a[14:15], v200 offset:3072
  s_waitcnt vmcnt(24)
  ds_read_b64_tr_b16 a[16:17], v199 offset:4096
  ds_read_b64_tr_b16 a[18:19], v199 offset:5120
  ds_read_b64_tr_b16 a[20:21], v200 offset:4096
  ds_read_b64_tr_b16 a[22:23], v200 offset:5120
  v_rcp_f32 v224, v224
  v_rcp_f32 v225, v225
  v_rcp_f32 v226, v226
  v_rcp_f32 v227, v227
  v_rcp_f32 v228, v228
  v_rcp_f32 v229, v229
  v_rcp_f32 v230, v230
  v_rcp_f32 v231, v231
  v_pk_mul_f32 v[224:225], v[224:225], v[24:25]
  v_pk_mul_f32 v[226:227], v[226:227], v[26:27]
  v_pk_mul_f32 v[228:229], v[228:229], v[28:29]
  v_pk_mul_f32 v[230:231], v[230:231], v[30:31]
  v_cvt_pk_bf16_f32 v236, v224, v225
  v_cvt_pk_bf16_f32 v237, v226, v227
  v_cvt_pk_bf16_f32 v238, v228, v229
  v_cvt_pk_bf16_f32 v239, v230, v231
  buffer_store_dwordx4 v[232:235], v2, s[28:31], s70 offen offset:0 sc1
  buffer_store_dwordx4 v[236:239], v2, s[28:31], s70 offen offset:1024 sc1
  s_add_u32 m0, s53, 49152
  s_nop 0
  buffer_load_dwordx4 v197, s[24:27], s51 offen lds
  buffer_load_dwordx4 v198, s[24:27], s51 offen offset:1024 lds
  s_add_u32 s51, s51, 16384
  v_pk_mul_f32 v[216:217], v[32:33], s[56:57]
  v_pk_mul_f32 v[218:219], v[34:35], s[56:57]
  v_pk_mul_f32 v[220:221], v[36:37], s[56:57]
  v_pk_mul_f32 v[222:223], v[38:39], s[56:57]
  v_exp_f32 v216, v216
  v_exp_f32 v217, v217
  v_exp_f32 v218, v218
  v_exp_f32 v219, v219
  v_exp_f32 v220, v220
  v_exp_f32 v221, v221
  v_exp_f32 v222, v222
  v_exp_f32 v223, v223
  v_pk_add_f32 v[216:217], v[216:217], s[58:59]
  v_pk_add_f32 v[218:219], v[218:219], s[58:59]
  v_pk_add_f32 v[220:221], v[220:221], s[58:59]
  v_pk_add_f32 v[222:223], v[222:223], s[58:59]
  s_waitcnt vmcnt(26)
  ds_read_b64_tr_b16 a[24:25], v199 offset:6144
  ds_read_b64_tr_b16 a[26:27], v199 offset:7168
  ds_read_b64_tr_b16 a[28:29], v200 offset:6144
  ds_read_b64_tr_b16 a[30:31], v200 offset:7168
  s_waitcnt vmcnt(24)
  ds_read_b64_tr_b16 a[32:33], v199 offset:8192
  ds_read_b64_tr_b16 a[34:35], v199 offset:9216
  ds_read_b64_tr_b16 a[36:37], v200 offset:8192
  ds_read_b64_tr_b16 a[38:39], v200 offset:9216
  v_rcp_f32 v216, v216
  v_rcp_f32 v217, v217
  v_rcp_f32 v218, v218
  v_rcp_f32 v219, v219
  v_rcp_f32 v220, v220
  v_rcp_f32 v221, v221
  v_rcp_f32 v222, v222
  v_rcp_f32 v223, v223
  v_pk_mul_f32 v[216:217], v[216:217], v[32:33]
  v_pk_mul_f32 v[218:219], v[218:219], v[34:35]
  v_pk_mul_f32 v[220:221], v[220:221], v[36:37]
  v_pk_mul_f32 v[222:223], v[222:223], v[38:39]
  v_cvt_pk_bf16_f32 v240, v216, v217
  v_cvt_pk_bf16_f32 v241, v218, v219
  v_cvt_pk_bf16_f32 v242, v220, v221
  v_cvt_pk_bf16_f32 v243, v222, v223
  buffer_store_dwordx4 v[240:243], v2, s[28:31], s71 offen offset:0 sc1
  s_add_u32 m0, s53, 51200
  s_nop 0
  buffer_load_dwordx4 v197, s[24:27], s51 offen lds
  buffer_load_dwordx4 v198, s[24:27], s51 offen offset:1024 lds
  s_add_u32 s51, s51, 16384
  v_pk_mul_f32 v[224:225], v[40:41], s[56:57]
  v_pk_mul_f32 v[226:227], v[42:43], s[56:57]
  v_pk_mul_f32 v[228:229], v[44:45], s[56:57]
  v_pk_mul_f32 v[230:231], v[46:47], s[56:57]
  v_exp_f32 v224, v224
  v_exp_f32 v225, v225
  v_exp_f32 v226, v226
  v_exp_f32 v227, v227
  v_exp_f32 v228, v228
  v_exp_f32 v229, v229
  v_exp_f32 v230, v230
  v_exp_f32 v231, v231
  v_pk_add_f32 v[224:225], v[224:225], s[58:59]
  v_pk_add_f32 v[226:227], v[226:227], s[58:59]
  v_pk_add_f32 v[228:229], v[228:229], s[58:59]
  v_pk_add_f32 v[230:231], v[230:231], s[58:59]
  s_waitcnt vmcnt(25)
  ds_read_b64_tr_b16 a[40:41], v199 offset:10240
  ds_read_b64_tr_b16 a[42:43], v199 offset:11264
  ds_read_b64_tr_b16 a[44:45], v200 offset:10240
  ds_read_b64_tr_b16 a[46:47], v200 offset:11264
  s_waitcnt vmcnt(23)
  ds_read_b64_tr_b16 a[48:49], v199 offset:12288
  ds_read_b64_tr_b16 a[50:51], v199 offset:13312
  ds_read_b64_tr_b16 a[52:53], v200 offset:12288
  ds_read_b64_tr_b16 a[54:55], v200 offset:13312
  v_rcp_f32 v224, v224
  v_rcp_f32 v225, v225
  v_rcp_f32 v226, v226
  v_rcp_f32 v227, v227
  v_rcp_f32 v228, v228
  v_rcp_f32 v229, v229
  v_rcp_f32 v230, v230
  v_rcp_f32 v231, v231
  v_pk_mul_f32 v[224:225], v[224:225], v[40:41]
  v_pk_mul_f32 v[226:227], v[226:227], v[42:43]
  v_pk_mul_f32 v[228:229], v[228:229], v[44:45]
  v_pk_mul_f32 v[230:231], v[230:231], v[46:47]
  v_cvt_pk_bf16_f32 v232, v224, v225
  v_cvt_pk_bf16_f32 v233, v226, v227
  v_cvt_pk_bf16_f32 v234, v228, v229
  v_cvt_pk_bf16_f32 v235, v230, v231
  buffer_store_dwordx4 v[232:235], v2, s[28:31], s71 offen offset:1024 sc1
  s_bfe_u32 s69, s48, 0x80018
  s_lshl_b32 s69, s69, 14
  s_add_u32 s51, s69, s100
  s_add_u32 m0, s53, 53248
  s_nop 0
  buffer_load_dwordx4 v197, s[24:27], s51 offen lds
  buffer_load_dwordx4 v198, s[24:27], s51 offen offset:1024 lds
  s_add_u32 s51, s51, 16384
  v_pk_mul_f32 v[216:217], v[48:49], s[56:57]
  v_pk_mul_f32 v[218:219], v[50:51], s[56:57]
  v_pk_mul_f32 v[220:221], v[52:53], s[56:57]
  v_pk_mul_f32 v[222:223], v[54:55], s[56:57]
  v_exp_f32 v216, v216
  v_exp_f32 v217, v217
  v_exp_f32 v218, v218
  v_exp_f32 v219, v219
  v_exp_f32 v220, v220
  v_exp_f32 v221, v221
  v_exp_f32 v222, v222
  v_exp_f32 v223, v223
  v_pk_add_f32 v[216:217], v[216:217], s[58:59]
  v_pk_add_f32 v[218:219], v[218:219], s[58:59]
  v_pk_add_f32 v[220:221], v[220:221], s[58:59]
  v_pk_add_f32 v[222:223], v[222:223], s[58:59]
  s_waitcnt vmcnt(24)
  ds_read_b64_tr_b16 a[56:57], v199 offset:14336
  ds_read_b64_tr_b16 a[58:59], v199 offset:15360
  ds_read_b64_tr_b16 a[60:61], v200 offset:14336
  ds_read_b64_tr_b16 a[62:63], v200 offset:15360
  s_waitcnt vmcnt(22)
  ds_read_b64_tr_b16 a[64:65], v201 offset:0
  ds_read_b64_tr_b16 a[66:67], v201 offset:1024
  ds_read_b64_tr_b16 a[68:69], v202 offset:0
  ds_read_b64_tr_b16 a[70:71], v202 offset:1024
  v_rcp_f32 v216, v216
  v_rcp_f32 v217, v217
  v_rcp_f32 v218, v218
  v_rcp_f32 v219, v219
  v_rcp_f32 v220, v220
  v_rcp_f32 v221, v221
  v_rcp_f32 v222, v222
  v_rcp_f32 v223, v223
  v_pk_mul_f32 v[216:217], v[216:217], v[48:49]
  v_pk_mul_f32 v[218:219], v[218:219], v[50:51]
  v_pk_mul_f32 v[220:221], v[220:221], v[52:53]
  v_pk_mul_f32 v[222:223], v[222:223], v[54:55]
  v_cvt_pk_bf16_f32 v236, v216, v217
  v_cvt_pk_bf16_f32 v237, v218, v219
  v_cvt_pk_bf16_f32 v238, v220, v221
  v_cvt_pk_bf16_f32 v239, v222, v223
  buffer_store_dwordx4 v[236:239], v2, s[28:31], s70 offen offset:2048 sc1
  s_waitcnt lgkmcnt(15)
  s_add_u32 m0, s52, 0
  s_nop 0
  buffer_load_dwordx4 v197, s[24:27], s51 offen lds
  buffer_load_dwordx4 v198, s[24:27], s51 offen offset:1024 lds
  s_add_u32 s51, s51, 16384
  v_pk_mul_f32 v[224:225], v[56:57], s[56:57]
  v_pk_mul_f32 v[226:227], v[58:59], s[56:57]
  v_pk_mul_f32 v[228:229], v[60:61], s[56:57]
  v_pk_mul_f32 v[230:231], v[62:63], s[56:57]
  v_exp_f32 v224, v224
  v_exp_f32 v225, v225
  v_exp_f32 v226, v226
  v_exp_f32 v227, v227
  v_exp_f32 v228, v228
  v_exp_f32 v229, v229
  v_exp_f32 v230, v230
  v_exp_f32 v231, v231
  v_pk_add_f32 v[224:225], v[224:225], s[58:59]
  v_pk_add_f32 v[226:227], v[226:227], s[58:59]
  v_pk_add_f32 v[228:229], v[228:229], s[58:59]
  v_pk_add_f32 v[230:231], v[230:231], s[58:59]
  s_waitcnt vmcnt(23)
  ds_read_b64_tr_b16 a[72:73], v201 offset:2048
  ds_read_b64_tr_b16 a[74:75], v201 offset:3072
  ds_read_b64_tr_b16 a[76:77], v202 offset:2048
  ds_read_b64_tr_b16 a[78:79], v202 offset:3072
  s_waitcnt vmcnt(21)
  ds_read_b64_tr_b16 a[80:81], v201 offset:4096
  ds_read_b64_tr_b16 a[82:83], v201 offset:5120
  ds_read_b64_tr_b16 a[84:85], v202 offset:4096
  ds_read_b64_tr_b16 a[86:87], v202 offset:5120
  v_rcp_f32 v224, v224
  v_rcp_f32 v225, v225
  v_rcp_f32 v226, v226
  v_rcp_f32 v227, v227
  v_rcp_f32 v228, v228
  v_rcp_f32 v229, v229
  v_rcp_f32 v230, v230
  v_rcp_f32 v231, v231
  v_pk_mul_f32 v[224:225], v[224:225], v[56:57]
  v_pk_mul_f32 v[226:227], v[226:227], v[58:59]
  v_pk_mul_f32 v[228:229], v[228:229], v[60:61]
  v_pk_mul_f32 v[230:231], v[230:231], v[62:63]
  v_cvt_pk_bf16_f32 v240, v224, v225
  v_cvt_pk_bf16_f32 v241, v226, v227
  v_cvt_pk_bf16_f32 v242, v228, v229
  v_cvt_pk_bf16_f32 v243, v230, v231
  buffer_store_dwordx4 v[240:243], v2, s[28:31], s70 offen offset:3072 sc1
  s_add_u32 m0, s52, 2048
  s_nop 0
  buffer_load_dwordx4 v197, s[24:27], s51 offen lds
  buffer_load_dwordx4 v198, s[24:27], s51 offen offset:1024 lds
  s_add_u32 s51, s51, 16384
  v_pk_mul_f32 v[216:217], v[64:65], s[56:57]
  v_pk_mul_f32 v[218:219], v[66:67], s[56:57]
  v_pk_mul_f32 v[220:221], v[68:69], s[56:57]
  v_pk_mul_f32 v[222:223], v[70:71], s[56:57]
  v_exp_f32 v216, v216
  v_exp_f32 v217, v217
  v_exp_f32 v218, v218
  v_exp_f32 v219, v219
  v_exp_f32 v220, v220
  v_exp_f32 v221, v221
  v_exp_f32 v222, v222
  v_exp_f32 v223, v223
  v_pk_add_f32 v[216:217], v[216:217], s[58:59]
  v_pk_add_f32 v[218:219], v[218:219], s[58:59]
  v_pk_add_f32 v[220:221], v[220:221], s[58:59]
  v_pk_add_f32 v[222:223], v[222:223], s[58:59]
  s_waitcnt vmcnt(22)
  ds_read_b64_tr_b16 a[88:89], v201 offset:6144
  ds_read_b64_tr_b16 a[90:91], v201 offset:7168
  ds_read_b64_tr_b16 a[92:93], v202 offset:6144
  ds_read_b64_tr_b16 a[94:95], v202 offset:7168
  s_waitcnt vmcnt(20)
  ds_read_b64_tr_b16 a[96:97], v201 offset:8192
  ds_read_b64_tr_b16 a[98:99], v201 offset:9216
  ds_read_b64_tr_b16 a[100:101], v202 offset:8192
  ds_read_b64_tr_b16 a[102:103], v202 offset:9216
  v_rcp_f32 v216, v216
  v_rcp_f32 v217, v217
  v_rcp_f32 v218, v218
  v_rcp_f32 v219, v219
  v_rcp_f32 v220, v220
  v_rcp_f32 v221, v221
  v_rcp_f32 v222, v222
  v_rcp_f32 v223, v223
  v_pk_mul_f32 v[216:217], v[216:217], v[64:65]
  v_pk_mul_f32 v[218:219], v[218:219], v[66:67]
  v_pk_mul_f32 v[220:221], v[220:221], v[68:69]
  v_pk_mul_f32 v[222:223], v[222:223], v[70:71]
  v_cvt_pk_bf16_f32 v232, v216, v217
  v_cvt_pk_bf16_f32 v233, v218, v219
  v_cvt_pk_bf16_f32 v234, v220, v221
  v_cvt_pk_bf16_f32 v235, v222, v223
  buffer_store_dwordx4 v[232:235], v2, s[28:31], s71 offen offset:2048 sc1
  v_readfirstlane_b32 s50, v205
  s_cmp_lg_u32 s50, 0
  s_cbranch_scc1 L_ok_1
L_retry_2:
  s_sub_u32 s75, s75, 1
  s_cmp_lt_i32 s75, 0
  s_cbranch_scc1 L_ok_1
  buffer_load_dword v205, v3, s[20:23], 0 offen sc1
  s_waitcnt vmcnt(0)
  v_readfirstlane_b32 s50, v205
  s_cmp_lg_u32 s50, 0
  s_cbranch_scc0 L_retry_2
L_ok_1:
  s_add_u32 m0, s52, 4096
  s_nop 0
  buffer_load_dwordx4 v197, s[24:27], s51 offen lds
  buffer_load_dwordx4 v198, s[24:27], s51 offen offset:1024 lds
  s_add_u32 s51, s51, 16384
  v_pk_mul_f32 v[224:225], v[72:73], s[56:57]
  v_pk_mul_f32 v[226:227], v[74:75], s[56:57]
  v_pk_mul_f32 v[228:229], v[76:77], s[56:57]
  v_pk_mul_f32 v[230:231], v[78:79], s[56:57]
  v_exp_f32 v224, v224
  v_exp_f32 v225, v225
  v_exp_f32 v226, v226
  v_exp_f32 v227, v227
  v_exp_f32 v228, v228
  v_exp_f32 v229, v229
  v_exp_f32 v230, v230
  v_exp_f32 v231, v231
  v_pk_add_f32 v[224:225], v[224:225], s[58:59]
  v_pk_add_f32 v[226:227], v[226:227], s[58:59]
  v_pk_add_f32 v[228:229], v[228:229], s[58:59]
  v_pk_add_f32 v[230:231], v[230:231], s[58:59]
  v_rcp_f32 v224, v224
  v_rcp_f32 v225, v225
  v_rcp_f32 v226, v226
  v_rcp_f32 v227, v227
  v_rcp_f32 v228, v228
  v_rcp_f32 v229, v229
  v_rcp_f32 v230, v230
  v_rcp_f32 v231, v231
  v_pk_mul_f32 v[224:225], v[224:225], v[72:73]
  v_pk_mul_f32 v[226:227], v[226:227], v[74:75]
  v_pk_mul_f32 v[228:229], v[228:229], v[76:77]
  v_pk_mul_f32 v[230:231], v[230:231], v[78:79]
  v_cvt_pk_bf16_f32 v236, v224, v225
  v_cvt_pk_bf16_f32 v237, v226, v227
  v_cvt_pk_bf16_f32 v238, v228, v229
  v_cvt_pk_bf16_f32 v239, v230, v231
  buffer_store_dwordx4 v[236:239], v2, s[28:31], s71 offen offset:3072 sc1
  s_bfe_u32 s69, s0, 0x80008
  s_lshl_b32 s69, s69, 14
  s_add_u32 s51, s69, s100
  s_add_u32 m0, s52, 6144
  s_nop 0
  buffer_load_dwordx4 v197, s[24:27], s51 offen lds
  buffer_load_dwordx4 v198, s[24:27], s51 offen offset:1024 lds
  s_add_u32 s51, s51, 16384
  v_pk_mul_f32 v[216:217], v[80:81], s[56:57]
  v_pk_mul_f32 v[218:219], v[82:83], s[56:57]
  v_pk_mul_f32 v[220:221], v[84:85], s[56:57]
  v_pk_mul_f32 v[222:223], v[86:87], s[56:57]
  v_exp_f32 v216, v216
  v_exp_f32 v217, v217
  v_exp_f32 v218, v218
  v_exp_f32 v219, v219
  v_exp_f32 v220, v220
  v_exp_f32 v221, v221
  v_exp_f32 v222, v222
  v_exp_f32 v223, v223
  v_pk_add_f32 v[216:217], v[216:217], s[58:59]
  v_pk_add_f32 v[218:219], v[218:219], s[58:59]
  v_pk_add_f32 v[220:221], v[220:221], s[58:59]
  v_pk_add_f32 v[222:223], v[222:223], s[58:59]
  v_rcp_f32 v216, v216
  v_rcp_f32 v217, v217
  v_rcp_f32 v218, v218
  v_rcp_f32 v219, v219
  v_rcp_f32 v220, v220
  v_rcp_f32 v221, v221
  v_rcp_f32 v222, v222
  v_rcp_f32 v223, v223
  v_pk_mul_f32 v[216:217], v[216:217], v[80:81]
  v_pk_mul_f32 v[218:219], v[218:219], v[82:83]
  v_pk_mul_f32 v[220:221], v[220:221], v[84:85]
  v_pk_mul_f32 v[222:223], v[222:223], v[86:87]
  v_cvt_pk_bf16_f32 v240, v216, v217
  v_cvt_pk_bf16_f32 v241, v218, v219
  v_cvt_pk_bf16_f32 v242, v220, v221
  v_cvt_pk_bf16_f32 v243, v222, v223
  s_mul_i32 s66, s38, -6144
  s_add_u32 s66, s66, 4096
  s_add_u32 s70, s70, s66
  s_add_u32 s71, s71, s66
  buffer_store_dwordx4 v[240:243], v2, s[28:31], s70 offen offset:0 sc1
  s_add_u32 m0, s52, 8192
  s_nop 0
  buffer_load_dwordx4 v197, s[24:27], s51 offen lds
  buffer_load_dwordx4 v198, s[24:27], s51 offen offset:1024 lds
  s_add_u32 s51, s51, 16384
  v_pk_mul_f32 v[224:225], v[88:89], s[56:57]
  v_pk_mul_f32 v[226:227], v[90:91], s[56:57]
  v_pk_mul_f32 v[228:229], v[92:93], s[56:57]
  v_pk_mul_f32 v[230:231], v[94:95], s[56:57]
  v_exp_f32 v224, v224
  v_exp_f32 v225, v225
  v_exp_f32 v226, v226
  v_exp_f32 v227, v227
  v_exp_f32 v228, v228
  v_exp_f32 v229, v229
  v_exp_f32 v230, v230
  v_exp_f32 v231, v231
  v_pk_add_f32 v[224:225], v[224:225], s[58:59]
  v_pk_add_f32 v[226:227], v[226:227], s[58:59]
  v_pk_add_f32 v[228:229], v[228:229], s[58:59]
  v_pk_add_f32 v[230:231], v[230:231], s[58:59]
  s_waitcnt vmcnt(27)
  ds_read_b64_tr_b16 a[104:105], v201 offset:45056
  ds_read_b64_tr_b16 a[106:107], v201 offset:46080
  ds_read_b64_tr_b16 a[108:109], v202 offset:45056
  ds_read_b64_tr_b16 a[110:111], v202 offset:46080
  s_waitcnt vmcnt(25)
  ds_read_b64_tr_b16 a[112:113], v201 offset:47104
  ds_read_b64_tr_b16 a[114:115], v201 offset:48128
  ds_read_b64_tr_b16 a[116:117], v202 offset:47104
  ds_read_b64_tr_b16 a[118:119], v202 offset:48128
  v_rcp_f32 v224, v224
  v_rcp_f32 v225, v225
  v_rcp_f32 v226, v226
  v_rcp_f32 v227, v227
  v_rcp_f32 v228, v228
  v_rcp_f32 v229, v229
  v_rcp_f32 v230, v230
  v_rcp_f32 v231, v231
  v_pk_mul_f32 v[224:225], v[224:225], v[88:89]
  v_pk_mul_f32 v[226:227], v[226:227], v[90:91]
  v_pk_mul_f32 v[228:229], v[228:229], v[92:93]
  v_pk_mul_f32 v[230:231], v[230:231], v[94:95]
  v_cvt_pk_bf16_f32 v232, v224, v225
  v_cvt_pk_bf16_f32 v233, v226, v227
  v_cvt_pk_bf16_f32 v234, v228, v229
  v_cvt_pk_bf16_f32 v235, v230, v231
  buffer_store_dwordx4 v[232:235], v2, s[28:31], s70 offen offset:1024 sc1
  s_waitcnt lgkmcnt(15)
  s_add_u32 m0, s52, 10240
  s_nop 0
  buffer_load_dwordx4 v197, s[24:27], s51 offen lds
  buffer_load_dwordx4 v198, s[24:27], s51 offen offset:1024 lds
  s_add_u32 s51, s51, 16384
  v_pk_mul_f32 v[216:217], v[96:97], s[56:57]
  v_pk_mul_f32 v[218:219], v[98:99], s[56:57]
  v_pk_mul_f32 v[220:221], v[100:101], s[56:57]
  v_pk_mul_f32 v[222:223], v[102:103], s[56:57]
  v_exp_f32 v216, v216
  v_exp_f32 v217, v217
  v_exp_f32 v218, v218
  v_exp_f32 v219, v219
  v_exp_f32 v220, v220
  v_exp_f32 v221, v221
  v_exp_f32 v222, v222
  v_exp_f32 v223, v223
  v_pk_add_f32 v[216:217], v[216:217], s[58:59]
  v_pk_add_f32 v[218:219], v[218:219], s[58:59]
  v_pk_add_f32 v[220:221], v[220:221], s[58:59]
  v_pk_add_f32 v[222:223], v[222:223], s[58:59]
  s_waitcnt vmcnt(24)
  ds_read_b64_tr_b16 a[120:121], v201 offset:49152
  ds_read_b64_tr_b16 a[122:123], v201 offset:50176
  ds_read_b64_tr_b16 a[124:125], v202 offset:49152
  ds_read_b64_tr_b16 a[126:127], v202 offset:50176
  s_waitcnt vmcnt(21)
  ds_read_b64_tr_b16 a[128:129], v201 offset:51200
  ds_read_b64_tr_b16 a[130:131], v201 offset:52224
  ds_read_b64_tr_b16 a[132:133], v202 offset:51200
  ds_read_b64_tr_b16 a[134:135], v202 offset:52224
  v_rcp_f32 v216, v216
  v_rcp_f32 v217, v217
  v_rcp_f32 v218, v218
  v_rcp_f32 v219, v219
  v_rcp_f32 v220, v220
  v_rcp_f32 v221, v221
  v_rcp_f32 v222, v222
  v_rcp_f32 v223, v223
  v_pk_mul_f32 v[216:217], v[216:217], v[96:97]
  v_pk_mul_f32 v[218:219], v[218:219], v[98:99]
  v_pk_mul_f32 v[220:221], v[220:221], v[100:101]
  v_pk_mul_f32 v[222:223], v[222:223], v[102:103]
  v_cvt_pk_bf16_f32 v236, v216, v217
  v_cvt_pk_bf16_f32 v237, v218, v219
  v_cvt_pk_bf16_f32 v238, v220, v221
  v_cvt_pk_bf16_f32 v239, v222, v223
  buffer_store_dwordx4 v[236:239], v2, s[28:31], s71 offen offset:0 sc1
  s_add_u32 s66, s93, 131072
  s_waitcnt vmcnt(9)
  s_mov_b64 exec, 1
  buffer_store_dword v205, v3, s[28:31], s66 offen sc1
  s_mov_b64 exec, -1
  s_bfe_u32 s69, s0, 0x80010
  s_lshl_b32 s69, s69, 14
  s_add_u32 s51, s69, s100
  s_add_u32 m0, s52, 12288
  s_nop 0
  buffer_load_dwordx4 v197, s[24:27], s51 offen lds
  buffer_load_dwordx4 v198, s[24:27], s51 offen offset:1024 lds
  s_add_u32 s51, s51, 16384
  v_pk_mul_f32 v[224:225], v[104:105], s[56:57]
  v_pk_mul_f32 v[226:227], v[106:107], s[56:57]
  v_pk_mul_f32 v[228:229], v[108:109], s[56:57]
  v_pk_mul_f32 v[230:231], v[110:111], s[56:57]
  v_exp_f32 v224, v224
  v_exp_f32 v225, v225
  v_exp_f32 v226, v226
  v_exp_f32 v227, v227
  v_exp_f32 v228, v228
  v_exp_f32 v229, v229
  v_exp_f32 v230, v230
  v_exp_f32 v231, v231
  v_pk_add_f32 v[224:225], v[224:225], s[58:59]
  v_pk_add_f32 v[226:227], v[226:227], s[58:59]
  v_pk_add_f32 v[228:229], v[228:229], s[58:59]
  v_pk_add_f32 v[230:231], v[230:231], s[58:59]
  ds_read_b64_tr_b16 a[136:137], v201 offset:53248
  ds_read_b64_tr_b16 a[138:139], v201 offset:54272
  ds_read_b64_tr_b16 a[140:141], v202 offset:53248
  ds_read_b64_tr_b16 a[142:143], v202 offset:54272
  v_rcp_f32 v224, v224
  v_rcp_f32 v225, v225
  v_rcp_f32 v226, v226
  v_rcp_f32 v227, v227
  v_rcp_f32 v228, v228
  v_rcp_f32 v229, v229
  v_rcp_f32 v230, v230
  v_rcp_f32 v231, v231
  v_pk_mul_f32 v[224:225], v[224:225], v[104:105]
  v_pk_mul_f32 v[226:227], v[226:227], v[106:107]
  v_pk_mul_f32 v[228:229], v[228:229], v[108:109]
  v_pk_mul_f32 v[230:231], v[230:231], v[110:111]
  v_cvt_pk_bf16_f32 v240, v224, v225
  v_cvt_pk_bf16_f32 v241, v226, v227
  v_cvt_pk_bf16_f32 v242, v228, v229
  v_cvt_pk_bf16_f32 v243, v230, v231
  buffer_store_dwordx4 v[240:243], v2, s[28:31], s71 offen offset:1024 sc1
  s_add_u32 m0, s52, 14336
  s_nop 0
  buffer_load_dwordx4 v197, s[24:27], s51 offen lds
  buffer_load_dwordx4 v198, s[24:27], s51 offen offset:1024 lds
  s_add_u32 s51, s51, 16384
  v_pk_mul_f32 v[216:217], v[112:113], s[56:57]
  v_pk_mul_f32 v[218:219], v[114:115], s[56:57]
  v_pk_mul_f32 v[220:221], v[116:117], s[56:57]
  v_pk_mul_f32 v[222:223], v[118:119], s[56:57]
  v_exp_f32 v216, v216
  v_exp_f32 v217, v217
  v_exp_f32 v218, v218
  v_exp_f32 v219, v219
  v_exp_f32 v220, v220
  v_exp_f32 v221, v221
  v_exp_f32 v222, v222
  v_exp_f32 v223, v223
  v_pk_add_f32 v[216:217], v[216:217], s[58:59]
  v_pk_add_f32 v[218:219], v[218:219], s[58:59]
  v_pk_add_f32 v[220:221], v[220:221], s[58:59]
  v_pk_add_f32 v[222:223], v[222:223], s[58:59]
  v_rcp_f32 v216, v216
  v_rcp_f32 v217, v217
  v_rcp_f32 v218, v218
  v_rcp_f32 v219, v219
  v_rcp_f32 v220, v220
  v_rcp_f32 v221, v221
  v_rcp_f32 v222, v222
  v_rcp_f32 v223, v223
  v_pk_mul_f32 v[216:217], v[216:217], v[112:113]
  v_pk_mul_f32 v[218:219], v[218:219], v[114:115]
  v_pk_mul_f32 v[220:221], v[220:221], v[116:117]
  v_pk_mul_f32 v[222:223], v[222:223], v[118:119]
  v_cvt_pk_bf16_f32 v232, v216, v217
  v_cvt_pk_bf16_f32 v233, v218, v219
  v_cvt_pk_bf16_f32 v234, v220, v221
  v_cvt_pk_bf16_f32 v235, v222, v223
  buffer_store_dwordx4 v[232:235], v2, s[28:31], s72 offen offset:0 sc1
  s_add_u32 m0, s53, 0
  s_nop 0
  buffer_load_dwordx4 v197, s[24:27], s51 offen lds
  buffer_load_dwordx4 v198, s[24:27], s51 offen offset:1024 lds
  s_add_u32 s51, s51, 16384
  v_pk_mul_f32 v[224:225], v[120:121], s[56:57]
  v_pk_mul_f32 v[226:227], v[122:123], s[56:57]
  v_pk_mul_f32 v[228:229], v[124:125], s[56:57]
  v_pk_mul_f32 v[230:231], v[126:127], s[56:57]
  v_exp_f32 v224, v224
  v_exp_f32 v225, v225
  v_exp_f32 v226, v226
  v_exp_f32 v227, v227
  v_exp_f32 v228, v228
  v_exp_f32 v229, v229
  v_exp_f32 v230, v230
  v_exp_f32 v231, v231
  v_pk_add_f32 v[224:225], v[224:225], s[58:59]
  v_pk_add_f32 v[226:227], v[226:227], s[58:59]
  v_pk_add_f32 v[228:229], v[228:229], s[58:59]
  v_pk_add_f32 v[230:231], v[230:231], s[58:59]
  v_rcp_f32 v224, v224
  v_rcp_f32 v225, v225
  v_rcp_f32 v226, v226
  v_rcp_f32 v227, v227
  v_rcp_f32 v228, v228
  v_rcp_f32 v229, v229
  v_rcp_f32 v230, v230
  v_rcp_f32 v231, v231
  v_pk_mul_f32 v[224:225], v[224:225], v[120:121]
  v_pk_mul_f32 v[226:227], v[226:227], v[122:123]
  v_pk_mul_f32 v[228:229], v[228:229], v[124:125]
  v_pk_mul_f32 v[230:231], v[230:231], v[126:127]
  v_cvt_pk_bf16_f32 v236, v224, v225
  v_cvt_pk_bf16_f32 v237, v226, v227
  v_cvt_pk_bf16_f32 v238, v228, v229
  v_cvt_pk_bf16_f32 v239, v230, v231
  buffer_store_dwordx4 v[236:239], v2, s[28:31], s72 offen offset:1024 sc1
  s_bfe_u32 s69, s0, 0x80018
  s_lshl_b32 s69, s69, 14
  s_add_u32 s51, s69, s100
  s_add_u32 m0, s53, 2048
  s_nop 0
  buffer_load_dwordx4 v197, s[24:27], s51 offen lds
  buffer_load_dwordx4 v198, s[24:27], s51 offen offset:1024 lds
  s_add_u32 s51, s51, 16384
  s_add_u32 m0, s53, 4096
  s_nop 0
  buffer_load_dwordx4 v197, s[24:27], s51 offen lds
  buffer_load_dwordx4 v198, s[24:27], s51 offen offset:1024 lds
  s_add_u32 s51, s51, 16384
  s_waitcnt lgkmcnt(15)
  s_add_u32 m0, s53, 6144
  s_nop 0
  buffer_load_dwordx4 v197, s[24:27], s51 offen lds
  buffer_load_dwordx4 v198, s[24:27], s51 offen offset:1024 lds
  s_add_u32 s51, s51, 16384
  s_bfe_u32 s69, s1, 0x80008
  s_lshl_b32 s69, s69, 14
  s_add_u32 s51, s69, s54
  s_add_u32 m0, s53, 8192
  s_nop 0
  buffer_load_dwordx4 v197, s[8:11], s51 offen lds
  buffer_load_dwordx4 v198, s[8:11], s51 offen offset:1024 lds
  s_add_u32 s51, s51, 16384
  s_add_u32 m0, s53, 45056
  s_nop 0
  buffer_load_dwordx4 v197, s[8:11], s51 offen lds
  buffer_load_dwordx4 v198, s[8:11], s51 offen offset:1024 lds
  s_add_u32 s51, s51, 16384
  s_waitcnt lgkmcnt(12)
  s_bfe_u32 s69, s1, 0x80010
  s_lshl_b32 s69, s69, 14
  s_add_u32 s51, s69, s54
  s_add_u32 m0, s53, 47104
  s_nop 0
  buffer_load_dwordx4 v197, s[8:11], s51 offen lds
  buffer_load_dwordx4 v198, s[8:11], s51 offen offset:1024 lds
  s_add_u32 s51, s51, 16384
  s_waitcnt lgkmcnt(8)
  s_add_u32 m0, s53, 49152
  s_nop 0
  buffer_load_dwordx4 v197, s[8:11], s51 offen lds
  buffer_load_dwordx4 v198, s[8:11], s51 offen offset:1024 lds
  s_add_u32 s51, s51, 16384
  s_waitcnt lgkmcnt(4)
  s_bfe_u32 s69, s1, 0x80018
  s_lshl_b32 s69, s69, 14
  s_add_u32 s51, s69, s54
  s_add_u32 m0, s53, 51200
  s_nop 0
  buffer_load_dwordx4 v197, s[8:11], s51 offen lds
  buffer_load_dwordx4 v198, s[8:11], s51 offen offset:1024 lds
  s_add_u32 s51, s51, 16384
  s_waitcnt lgkmcnt(0)
  s_add_u32 m0, s53, 53248
  s_nop 0
  buffer_load_dwordx4 v197, s[8:11], s51 offen lds
  buffer_load_dwordx4 v198, s[8:11], s51 offen offset:1024 lds
  s_add_u32 s51, s51, 16384
  s_add_u32 s85, s94, 131072
  buffer_load_dword v204, v203, s[28:31], s85 offen sc1
  s_mul_i32 s66, s36, 20480
  s_add_u32 s84, s96, s66
  s_sub_u32 s84, s84, 114688
  s_waitcnt vmcnt(19)
  s_mov_b64 exec, 1
  buffer_store_dword v205, v3, s[28:31], s93 offen sc1
  s_mov_b64 exec, -1
  s_waitcnt vmcnt(1)
  v_cmp_ne_u32 vcc, s50, v204
  s_nop 4
  s_cbranch_vccz L_ok_3
L_retry_4:
  s_sub_u32 s75, s75, 1
  s_cmp_lt_i32 s75, 0
  s_cbranch_scc1 L_ok_3
  buffer_load_dword v204, v203, s[28:31], s85 offen sc1
  s_waitcnt vmcnt(0)
  v_cmp_ne_u32 vcc, s50, v204
  s_nop 4
  s_cbranch_vccnz L_retry_4
L_ok_3:
  s_bfe_u32 s68, s48, 0x80000
  s_lshl_b32 s68, s68, 10
  s_add_u32 s73, s68, s84
  buffer_load_dwordx4 a[144:147], v2, s[28:31], s73 offen offset:0 sc1
  s_add_u32 s74, s73, 147456
  buffer_load_dwordx4 a[148:151], v2, s[28:31], s74 offen offset:0 sc1
  buffer_load_dwordx4 a[152:155], v2, s[28:31], s73 offen offset:1024 sc1
  buffer_load_dwordx4 a[156:159], v2, s[28:31], s74 offen offset:1024 sc1
  buffer_load_dwordx4 a[160:163], v2, s[28:31], s73 offen offset:2048 sc1
  buffer_load_dwordx4 a[164:167], v2, s[28:31], s74 offen offset:2048 sc1
  buffer_load_dwordx4 a[168:171], v2, s[28:31], s73 offen offset:3072 sc1
  buffer_load_dwordx4 a[172:175], v2, s[28:31], s74 offen offset:3072 sc1
  s_bfe_u32 s68, s48, 0x80008
  s_lshl_b32 s68, s68, 10
  s_add_u32 s73, s68, s84
  buffer_load_dwordx4 a[176:179], v2, s[28:31], s73 offen offset:0 sc1
  s_add_u32 s74, s73, 147456
  buffer_load_dwordx4 a[180:183], v2, s[28:31], s74 offen offset:0 sc1
  buffer_load_dwordx4 a[184:187], v2, s[28:31], s73 offen offset:1024 sc1
  buffer_load_dwordx4 a[188:191], v2, s[28:31], s74 offen offset:1024 sc1
  buffer_load_dwordx4 a[192:195], v2, s[28:31], s73 offen offset:2048 sc1
  buffer_load_dwordx4 a[196:199], v2, s[28:31], s74 offen offset:2048 sc1
  buffer_load_dwordx4 a[200:203], v2, s[28:31], s73 offen offset:3072 sc1
  buffer_load_dwordx4 a[204:207], v2, s[28:31], s74 offen offset:3072 sc1
  s_waitcnt vmcnt(15)
  v_mfma_f32_32x32x16_bf16 v[16:31], a[144:147], a[0:3], 0
  v_mfma_f32_32x32x16_bf16 v[32:47], a[144:147], a[4:7], 0
  s_bfe_u32 s68, s48, 0x80010
  s_lshl_b32 s68, s68, 10
  s_add_u32 s73, s68, s84
  buffer_load_dwordx4 a[208:211], v2, s[28:31], s73 offen offset:0 sc1
  s_waitcnt vmcnt(15)
  v_mfma_f32_32x32x16_bf16 v[48:63], a[148:151], a[0:3], 0
  v_mfma_f32_32x32x16_bf16 v[64:79], a[148:151], a[4:7], 0
  s_add_u32 s74, s73, 147456
  buffer_load_dwordx4 a[212:215], v2, s[28:31], s74 offen offset:0 sc1
  s_waitcnt vmcnt(15)
  v_mfma_f32_32x32x16_bf16 v[16:31], a[152:155], a[8:11], v[16:31]
  v_mfma_f32_32x32x16_bf16 v[32:47], a[152:155], a[12:15], v[32:47]
  buffer_load_dwordx4 a[216:219], v2, s[28:31], s73 offen offset:1024 sc1
  s_waitcnt vmcnt(15)
  v_mfma_f32_32x32x16_bf16 v[48:63], a[156:159], a[8:11], v[48:63]
  v_mfma_f32_32x32x16_bf16 v[64:79], a[156:159], a[12:15], v[64:79]
  buffer_load_dwordx4 a[220:223], v2, s[28:31], s74 offen offset:1024 sc1
  s_waitcnt vmcnt(15)
  v_mfma_f32_32x32x16_bf16 v[16:31], a[160:163], a[16:19], v[16:31]
  v_mfma_f32_32x32x16_bf16 v[32:47], a[160:163], a[20:23], v[32:47]
  buffer_load_dwordx4 a[224:227], v2, s[28:31], s73 offen offset:2048 sc1
  s_waitcnt vmcnt(15)
  v_mfma_f32_32x32x16_bf16 v[48:63], a[164:167], a[16:19], v[48:63]
  v_mfma_f32_32x32x16_bf16 v[64:79], a[164:167], a[20:23], v[64:79]
  buffer_load_dwordx4 a[228:231], v2, s[28:31], s74 offen offset:2048 sc1
  s_waitcnt vmcnt(15)
  v_mfma_f32_32x32x16_bf16 v[16:31], a[168:171], a[24:27], v[16:31]
  v_mfma_f32_32x32x16_bf16 v[32:47], a[168:171], a[28:31], v[32:47]
  buffer_load_dwordx4 a[232:235], v2, s[28:31], s73 offen offset:3072 sc1
  s_waitcnt vmcnt(15)
  v_mfma_f32_32x32x16_bf16 v[48:63], a[172:175], a[24:27], v[48:63]
  v_mfma_f32_32x32x16_bf16 v[64:79], a[172:175], a[28:31], v[64:79]
  buffer_load_dwordx4 a[236:239], v2, s[28:31], s74 offen offset:3072 sc1
  buffer_load_dword v204, v203, s[28:31], s94 offen sc1
  s_waitcnt vmcnt(16)
  v_mfma_f32_32x32x16_bf16 v[16:31], a[176:179], a[72:75], v[16:31]
  v_mfma_f32_32x32x16_bf16 v[32:47], a[176:179], a[76:79], v[32:47]
  s_bfe_u32 s68, s48, 0x80018
  s_lshl_b32 s68, s68, 10
  s_add_u32 s73, s68, s84
  buffer_load_dwordx4 a[240:243], v2, s[28:31], s73 offen offset:0 sc1
  s_waitcnt vmcnt(16)
  v_mfma_f32_32x32x16_bf16 v[48:63], a[180:183], a[72:75], v[48:63]
  v_mfma_f32_32x32x16_bf16 v[64:79], a[180:183], a[76:79], v[64:79]
  s_add_u32 s74, s73, 147456
  buffer_load_dwordx4 a[244:247], v2, s[28:31], s74 offen offset:0 sc1
  s_waitcnt vmcnt(16)
  v_mfma_f32_32x32x16_bf16 v[16:31], a[184:187], a[80:83], v[16:31]
  v_mfma_f32_32x32x16_bf16 v[32:47], a[184:187], a[84:87], v[32:47]
  buffer_load_dwordx4 a[248:251], v2, s[28:31], s73 offen offset:1024 sc1
  s_waitcnt vmcnt(16)
  v_mfma_f32_32x32x16_bf16 v[48:63], a[188:191], a[80:83], v[48:63]
  v_mfma_f32_32x32x16_bf16 v[64:79], a[188:191], a[84:87], v[64:79]
  buffer_load_dwordx4 a[252:255], v2, s[28:31], s74 offen offset:1024 sc1
  s_waitcnt vmcnt(16)
  v_mfma_f32_32x32x16_bf16 v[16:31], a[192:195], a[88:91], v[16:31]
  v_mfma_f32_32x32x16_bf16 v[32:47], a[192:195], a[92:95], v[32:47]
  buffer_load_dwordx4 a[144:147], v2, s[28:31], s73 offen offset:2048 sc1
  s_waitcnt vmcnt(16)
  v_mfma_f32_32x32x16_bf16 v[48:63], a[196:199], a[88:91], v[48:63]
  v_mfma_f32_32x32x16_bf16 v[64:79], a[196:199], a[92:95], v[64:79]
  buffer_load_dwordx4 a[148:151], v2, s[28:31], s74 offen offset:2048 sc1
  s_waitcnt vmcnt(16)
  v_mfma_f32_32x32x16_bf16 v[16:31], a[200:203], a[96:99], v[16:31]
  v_mfma_f32_32x32x16_bf16 v[32:47], a[200:203], a[100:103], v[32:47]
  buffer_load_dwordx4 a[152:155], v2, s[28:31], s73 offen offset:3072 sc1
  s_waitcnt vmcnt(16)
  v_mfma_f32_32x32x16_bf16 v[48:63], a[204:207], a[96:99], v[48:63]
  v_mfma_f32_32x32x16_bf16 v[64:79], a[204:207], a[100:103], v[64:79]
  buffer_load_dwordx4 a[156:159], v2, s[28:31], s74 offen offset:3072 sc1
  s_waitcnt vmcnt(16)
  v_mfma_f32_32x32x16_bf16 v[16:31], a[208:211], a[104:107], v[16:31]
  s_waitcnt vmcnt(8)
  v_cmp_ne_u32 vcc, s50, v204
  s_nop 4
  s_cbranch_vccz L_ok_5
L_retry_6:
  s_sub_u32 s75, s75, 1
  s_cmp_lt_i32 s75, 0
  s_cbranch_scc1 L_ok_5
  buffer_load_dword v204, v203, s[28:31], s94 offen sc1
  s_waitcnt vmcnt(0)
  v_cmp_ne_u32 vcc, s50, v204
  s_nop 4
  s_cbranch_vccnz L_retry_6
L_ok_5:
  v_mfma_f32_32x32x16_bf16 v[32:47], a[208:211], a[108:111], v[32:47]
  s_bfe_u32 s68, s0, 0x80000
  s_lshl_b32 s68, s68, 10
  s_add_u32 s73, s68, s84
  buffer_load_dwordx4 a[160:163], v2, s[28:31], s73 offen offset:0 sc1
  v_mfma_f32_32x32x16_bf16 v[48:63], a[212:215], a[104:107], v[48:63]
  v_mfma_f32_32x32x16_bf16 v[64:79], a[212:215], a[108:111], v[64:79]
  s_add_u32 s74, s73, 147456
  buffer_load_dwordx4 a[164:167], v2, s[28:31], s74 offen offset:0 sc1
  v_mfma_f32_32x32x16_bf16 v[16:31], a[216:219], a[112:115], v[16:31]
  v_mfma_f32_32x32x16_bf16 v[32:47], a[216:219], a[116:119], v[32:47]
  buffer_load_dwordx4 a[168:171], v2, s[28:31], s73 offen offset:1024 sc1
  v_mfma_f32_32x32x16_bf16 v[48:63], a[220:223], a[112:115], v[48:63]
  v_mfma_f32_32x32x16_bf16 v[64:79], a[220:223], a[116:119], v[64:79]
  buffer_load_dwordx4 a[172:175], v2, s[28:31], s74 offen offset:1024 sc1
  v_mfma_f32_32x32x16_bf16 v[16:31], a[224:227], a[120:123], v[16:31]
  v_mfma_f32_32x32x16_bf16 v[32:47], a[224:227], a[124:127], v[32:47]
  buffer_load_dwordx4 a[176:179], v2, s[28:31], s73 offen offset:2048 sc1
  v_mfma_f32_32x32x16_bf16 v[48:63], a[228:231], a[120:123], v[48:63]
  v_mfma_f32_32x32x16_bf16 v[64:79], a[228:231], a[124:127], v[64:79]
  buffer_load_dwordx4 a[180:183], v2, s[28:31], s74 offen offset:2048 sc1
  v_mfma_f32_32x32x16_bf16 v[16:31], a[232:235], a[128:131], v[16:31]
  v_mfma_f32_32x32x16_bf16 v[32:47], a[232:235], a[132:135], v[32:47]
  s_bfe_u32 s68, s0, 0x80008
  s_lshl_b32 s68, s68, 10
  s_add_u32 s73, s68, s84
  buffer_load_dwordx4 a[184:187], v2, s[28:31], s73 offen offset:0 sc1
  v_mfma_f32_32x32x16_bf16 v[48:63], a[236:239], a[128:131], v[48:63]
  v_mfma_f32_32x32x16_bf16 v[64:79], a[236:239], a[132:135], v[64:79]
  s_add_u32 s74, s73, 147456
  buffer_load_dwordx4 a[188:191], v2, s[28:31], s74 offen offset:0 sc1
  s_waitcnt vmcnt(15)
  v_mfma_f32_32x32x16_bf16 v[16:31], a[240:243], a[136:139], v[16:31]
  ds_read_b64_tr_b16 v[152:153], v199 offset:0
  ds_read_b64_tr_b16 v[154:155], v199 offset:1024
  v_mfma_f32_32x32x16_bf16 v[32:47], a[240:243], a[140:143], v[32:47]
  ds_read_b64_tr_b16 v[156:157], v200 offset:0
  ds_read_b64_tr_b16 v[158:159], v200 offset:1024
  buffer_load_dwordx4 a[192:195], v2, s[28:31], s73 offen offset:1024 sc1
  s_waitcnt vmcnt(15)
  v_mfma_f32_32x32x16_bf16 v[48:63], a[244:247], a[136:139], v[48:63]
  v_mfma_f32_32x32x16_bf16 v[64:79], a[244:247], a[140:143], v[64:79]
  buffer_load_dwordx4 a[196:199], v2, s[28:31], s74 offen offset:1024 sc1
  buffer_load_dword v204, v203, s[28:31], s95 offen sc1
  s_waitcnt vmcnt(16) lgkmcnt(2)
  v_mfma_f32_32x32x16_bf16 v[16:31], a[248:251], v[152:155], v[16:31]
  ds_read_b64_tr_b16 v[144:145], v199 offset:2048
  ds_read_b64_tr_b16 v[146:147], v199 offset:3072
  s_waitcnt lgkmcnt(2)
  v_mfma_f32_32x32x16_bf16 v[32:47], a[248:251], v[156:159], v[32:47]
  ds_read_b64_tr_b16 v[148:149], v200 offset:2048
  ds_read_b64_tr_b16 v[150:151], v200 offset:3072
  buffer_load_dwordx4 a[200:203], v2, s[28:31], s73 offen offset:2048 sc1
  s_waitcnt vmcnt(16)
  v_mfma_f32_32x32x16_bf16 v[48:63], a[252:255], v[152:155], v[48:63]
  v_mfma_f32_32x32x16_bf16 v[64:79], a[252:255], v[156:159], v[64:79]
  buffer_load_dwordx4 a[204:207], v2, s[28:31], s74 offen offset:2048 sc1
  s_waitcnt vmcnt(16) lgkmcnt(2)
  v_mfma_f32_32x32x16_bf16 v[16:31], a[144:147], v[144:147], v[16:31]
  ds_read_b64_tr_b16 v[152:153], v199 offset:4096
  ds_read_b64_tr_b16 v[154:155], v199 offset:5120
  s_waitcnt lgkmcnt(2)
  v_mfma_f32_32x32x16_bf16 v[32:47], a[144:147], v[148:151], v[32:47]
  ds_read_b64_tr_b16 v[156:157], v200 offset:4096
  ds_read_b64_tr_b16 v[158:159], v200 offset:5120
  s_bfe_u32 s68, s0, 0x80010
  s_lshl_b32 s68, s68, 10
  s_add_u32 s73, s68, s84
  buffer_load_dwordx4 a[208:211], v2, s[28:31], s73 offen offset:0 sc1
  s_waitcnt vmcnt(16)
  v_mfma_f32_32x32x16_bf16 v[48:63], a[148:151], v[144:147], v[48:63]
  v_mfma_f32_32x32x16_bf16 v[64:79], a[148:151], v[148:151], v[64:79]
  s_add_u32 s74, s73, 147456
  buffer_load_dwordx4 a[212:215], v2, s[28:31], s74 offen offset:0 sc1
  s_waitcnt vmcnt(16) lgkmcnt(2)
  v_mfma_f32_32x32x16_bf16 v[16:31], a[152:155], v[152:155], v[16:31]
  s_waitcnt lgkmcnt(0)
  v_mfma_f32_32x32x16_bf16 v[32:47], a[152:155], v[156:159], v[32:47]
  buffer_load_dwordx4 a[216:219], v2, s[28:31], s73 offen offset:1024 sc1
  s_waitcnt vmcnt(16)
  v_mfma_f32_32x32x16_bf16 v[48:63], a[156:159], v[152:155], v[48:63]
  v_mfma_f32_32x32x16_bf16 v[64:79], a[156:159], v[156:159], v[64:79]
  buffer_load_dwordx4 a[220:223], v2, s[28:31], s74 offen offset:1024 sc1
  s_waitcnt vmcnt(16)
  v_mfma_f32_32x32x16_bf16 v[16:31], a[160:163], a[32:35], v[16:31]
  v_mfma_f32_32x32x16_bf16 v[32:47], a[160:163], a[36:39], v[32:47]
  buffer_load_dwordx4 a[224:227], v2, s[28:31], s73 offen offset:2048 sc1
  s_waitcnt vmcnt(16)
  v_mfma_f32_32x32x16_bf16 v[48:63], a[164:167], a[32:35], v[48:63]
  v_mfma_f32_32x32x16_bf16 v[64:79], a[164:167], a[36:39], v[64:79]
  buffer_load_dwordx4 a[228:231], v2, s[28:31], s74 offen offset:2048 sc1
  s_waitcnt vmcnt(16)
  v_mfma_f32_32x32x16_bf16 v[16:31], a[168:171], a[40:43], v[16:31]
  v_mfma_f32_32x32x16_bf16 v[32:47], a[168:171], a[44:47], v[32:47]
  s_bfe_u32 s68, s0, 0x80018
  s_lshl_b32 s68, s68, 10
  s_add_u32 s73, s68, s84
  buffer_load_dwordx4 a[232:235], v2, s[28:31], s73 offen offset:0 sc1
  s_waitcnt vmcnt(16)
  v_mfma_f32_32x32x16_bf16 v[48:63], a[172:175], a[40:43], v[48:63]
  v_mfma_f32_32x32x16_bf16 v[64:79], a[172:175], a[44:47], v[64:79]
  s_add_u32 s74, s73, 147456
  buffer_load_dwordx4 a[236:239], v2, s[28:31], s74 offen offset:0 sc1
  s_waitcnt vmcnt(16)
  v_mfma_f32_32x32x16_bf16 v[16:31], a[176:179], a[48:51], v[16:31]
  ds_read_b64_tr_b16 v[152:153], v199 offset:6144
  ds_read_b64_tr_b16 v[154:155], v199 offset:7168
  v_mfma_f32_32x32x16_bf16 v[32:47], a[176:179], a[52:55], v[32:47]
  ds_read_b64_tr_b16 v[156:157], v200 offset:6144
  ds_read_b64_tr_b16 v[158:159], v200 offset:7168
  buffer_load_dwordx4 a[240:243], v2, s[28:31], s73 offen offset:1024 sc1
  s_waitcnt vmcnt(16)
  v_mfma_f32_32x32x16_bf16 v[48:63], a[180:183], a[48:51], v[48:63]
  v_mfma_f32_32x32x16_bf16 v[64:79], a[180:183], a[52:55], v[64:79]
  buffer_load_dwordx4 a[244:247], v2, s[28:31], s74 offen offset:1024 sc1
  s_waitcnt vmcnt(16) lgkmcnt(2)
  v_mfma_f32_32x32x16_bf16 v[16:31], a[184:187], v[152:155], v[16:31]
  ds_read_b64_tr_b16 v[144:145], v199 offset:8192
  ds_read_b64_tr_b16 v[146:147], v199 offset:9216
  s_waitcnt lgkmcnt(2)
  v_mfma_f32_32x32x16_bf16 v[32:47], a[184:187], v[156:159], v[32:47]
  ds_read_b64_tr_b16 v[148:149], v200 offset:8192
  ds_read_b64_tr_b16 v[150:151], v200 offset:9216
  buffer_load_dwordx4 a[248:251], v2, s[28:31], s73 offen offset:2048 sc1
  s_waitcnt vmcnt(16)
  v_mfma_f32_32x32x16_bf16 v[48:63], a[188:191], v[152:155], v[48:63]
  v_mfma_f32_32x32x16_bf16 v[64:79], a[188:191], v[156:159], v[64:79]
  buffer_load_dwordx4 a[252:255], v2, s[28:31], s74 offen offset:2048 sc1
  s_waitcnt vmcnt(16) lgkmcnt(2)
  v_mfma_f32_32x32x16_bf16 v[16:31], a[192:195], v[144:147], v[16:31]
  ds_read_b64_tr_b16 v[152:153], v199 offset:10240
  ds_read_b64_tr_b16 v[154:155], v199 offset:11264
  s_waitcnt vmcnt(14)
  v_cmp_ne_u32 vcc, s50, v204
  s_nop 4
  s_cbranch_vccz L_ok_7
L_retry_8:
  s_sub_u32 s75, s75, 1
  s_cmp_lt_i32 s75, 0
  s_cbranch_scc1 L_ok_7
  buffer_load_dword v204, v203, s[28:31], s95 offen sc1
  s_waitcnt vmcnt(0)
  v_cmp_ne_u32 vcc, s50, v204
  s_nop 4
  s_cbranch_vccnz L_retry_8
L_ok_7:
  buffer_load_dword v209, v206, s[28:31], s97 offen sc1
  s_waitcnt lgkmcnt(2)
  v_mfma_f32_32x32x16_bf16 v[32:47], a[192:195], v[148:151], v[32:47]
  ds_read_b64_tr_b16 v[156:157], v200 offset:10240
  ds_read_b64_tr_b16 v[158:159], v200 offset:11264
  s_bfe_u32 s68, s1, 0x80000
  s_lshl_b32 s68, s68, 10
  s_add_u32 s73, s68, s96
  buffer_load_dwordx4 a[144:147], v2, s[28:31], s73 offen offset:0 sc1
  v_mfma_f32_32x32x16_bf16 v[48:63], a[196:199], v[144:147], v[48:63]
  v_mfma_f32_32x32x16_bf16 v[64:79], a[196:199], v[148:151], v[64:79]
  s_add_u32 s74, s73, 147456
  buffer_load_dwordx4 a[148:151], v2, s[28:31], s74 offen offset:0 sc1
  s_waitcnt vmcnt(16) lgkmcnt(2)
  v_mfma_f32_32x32x16_bf16 v[16:31], a[200:203], v[152:155], v[16:31]
  ds_read_b64_tr_b16 v[144:145], v199 offset:12288
  ds_read_b64_tr_b16 v[146:147], v199 offset:13312
  s_waitcnt lgkmcnt(2)
  v_mfma_f32_32x32x16_bf16 v[32:47], a[200:203], v[156:159], v[32:47]
  ds_read_b64_tr_b16 v[148:149], v200 offset:12288
  ds_read_b64_tr_b16 v[150:151], v200 offset:13312
  buffer_load_dwordx4 a[152:155], v2, s[28:31], s73 offen offset:1024 sc1
  s_waitcnt vmcnt(16)
  v_mfma_f32_32x32x16_bf16 v[48:63], a[204:207], v[152:155], v[48:63]
  v_mfma_f32_32x32x16_bf16 v[64:79], a[204:207], v[156:159], v[64:79]
  buffer_load_dwordx4 a[156:159], v2, s[28:31], s74 offen offset:1024 sc1
  s_waitcnt vmcnt(16) lgkmcnt(2)
  v_mfma_f32_32x32x16_bf16 v[16:31], a[208:211], v[144:147], v[16:31]
  ds_read_b64_tr_b16 v[152:153], v199 offset:14336
  ds_read_b64_tr_b16 v[154:155], v199 offset:15360
  s_waitcnt lgkmcnt(2)
  v_mfma_f32_32x32x16_bf16 v[32:47], a[208:211], v[148:151], v[32:47]
  ds_read_b64_tr_b16 v[156:157], v200 offset:14336
  ds_read_b64_tr_b16 v[158:159], v200 offset:15360
  s_bfe_u32 s68, s1, 0x80008
  s_lshl_b32 s68, s68, 10
  s_add_u32 s73, s68, s96
  buffer_load_dwordx4 a[160:163], v2, s[28:31], s73 offen offset:0 sc1
  s_waitcnt vmcnt(16)
  v_mfma_f32_32x32x16_bf16 v[48:63], a[212:215], v[144:147], v[48:63]
  v_mfma_f32_32x32x16_bf16 v[64:79], a[212:215], v[148:151], v[64:79]
  s_add_u32 s74, s73, 147456
  buffer_load_dwordx4 a[164:167], v2, s[28:31], s74 offen offset:0 sc1
  s_waitcnt vmcnt(16) lgkmcnt(2)
  v_mfma_f32_32x32x16_bf16 v[16:31], a[216:219], v[152:155], v[16:31]
  ds_read_b64_tr_b16 v[144:145], v201 offset:0
  ds_read_b64_tr_b16 v[146:147], v201 offset:1024
  s_waitcnt lgkmcnt(2)
  v_mfma_f32_32x32x16_bf16 v[32:47], a[216:219], v[156:159], v[32:47]
  ds_read_b64_tr_b16 v[148:149], v202 offset:0
  ds_read_b64_tr_b16 v[150:151], v202 offset:1024
  buffer_load_dwordx4 a[168:171], v2, s[28:31], s73 offen offset:1024 sc1
  s_waitcnt vmcnt(16)
  v_mfma_f32_32x32x16_bf16 v[48:63], a[220:223], v[152:155], v[48:63]
  v_mfma_f32_32x32x16_bf16 v[64:79], a[220:223], v[156:159], v[64:79]
  buffer_load_dwordx4 a[172:175], v2, s[28:31], s74 offen offset:1024 sc1
  s_waitcnt vmcnt(16) lgkmcnt(2)
  v_mfma_f32_32x32x16_bf16 v[16:31], a[224:227], v[144:147], v[16:31]
  ds_read_b64_tr_b16 v[152:153], v201 offset:2048
  ds_read_b64_tr_b16 v[154:155], v201 offset:3072
  s_waitcnt lgkmcnt(2)
  v_mfma_f32_32x32x16_bf16 v[32:47], a[224:227], v[148:151], v[32:47]
  ds_read_b64_tr_b16 v[156:157], v202 offset:2048
  ds_read_b64_tr_b16 v[158:159], v202 offset:3072
  s_bfe_u32 s68, s1, 0x80010
  s_lshl_b32 s68, s68, 10
  s_add_u32 s73, s68, s96
  buffer_load_dwordx4 a[176:179], v2, s[28:31], s73 offen offset:0 sc1
  s_waitcnt vmcnt(16)
  v_mfma_f32_32x32x16_bf16 v[48:63], a[228:231], v[144:147], v[48:63]
  s_waitcnt vmcnt(9)
  ds_write_b32 v207, v209
  v_mfma_f32_32x32x16_bf16 v[64:79], a[228:231], v[148:151], v[64:79]
  s_add_u32 s74, s73, 147456
  buffer_load_dwordx4 a[180:183], v2, s[28:31], s74 offen offset:0 sc1
  s_waitcnt lgkmcnt(3)
  v_mfma_f32_32x32x16_bf16 v[16:31], a[232:235], v[152:155], v[16:31]
  ds_read_b64_tr_b16 v[144:145], v201 offset:4096
  ds_read_b64_tr_b16 v[146:147], v201 offset:5120
  s_waitcnt lgkmcnt(3)
  v_mfma_f32_32x32x16_bf16 v[32:47], a[232:235], v[156:159], v[32:47]
  ds_read_b64_tr_b16 v[148:149], v202 offset:4096
  ds_read_b64_tr_b16 v[150:151], v202 offset:5120
  buffer_load_dwordx4 a[184:187], v2, s[28:31], s73 offen offset:1024 sc1
  v_mfma_f32_32x32x16_bf16 v[48:63], a[236:239], v[152:155], v[48:63]
  s_waitcnt lgkmcnt(4)
  ds_read_b128 v[80:83], v208 offset:0
  ds_read_b128 v[84:87], v208 offset:32
  ds_read_b128 v[88:91], v208 offset:64
  ds_read_b128 v[92:95], v208 offset:96
  v_mfma_f32_32x32x16_bf16 v[64:79], a[236:239], v[156:159], v[64:79]
  buffer_load_dwordx4 a[188:191], v2, s[28:31], s74 offen offset:1024 sc1
  ds_read_b128 v[96:99], v208 offset:128
  ds_read_b128 v[100:103], v208 offset:160
  ds_read_b128 v[104:107], v208 offset:192
  ds_read_b128 v[108:111], v208 offset:224
  s_waitcnt lgkmcnt(10)
  v_mfma_f32_32x32x16_bf16 v[16:31], a[240:243], v[144:147], v[16:31]
  ds_read_b64_tr_b16 v[152:153], v201 offset:6144
  ds_read_b64_tr_b16 v[154:155], v201 offset:7168
  s_waitcnt lgkmcnt(10)
  v_mfma_f32_32x32x16_bf16 v[32:47], a[240:243], v[148:151], v[32:47]
  ds_read_b64_tr_b16 v[156:157], v202 offset:6144
  ds_read_b64_tr_b16 v[158:159], v202 offset:7168
  s_bfe_u32 s68, s1, 0x80018
  s_lshl_b32 s68, s68, 10
  s_add_u32 s73, s68, s96
  buffer_load_dwordx4 a[192:195], v2, s[28:31], s73 offen offset:0 sc1
  v_mfma_f32_32x32x16_bf16 v[48:63], a[244:247], v[144:147], v[48:63]
  v_mfma_f32_32x32x16_bf16 v[64:79], a[244:247], v[148:151], v[64:79]
  s_add_u32 s74, s73, 147456
  buffer_load_dwordx4 a[196:199], v2, s[28:31], s74 offen offset:0 sc1
  s_waitcnt lgkmcnt(2)
  v_mfma_f32_32x32x16_bf16 v[16:31], a[248:251], v[152:155], v[16:31]
  s_waitcnt lgkmcnt(0)
  v_mfma_f32_32x32x16_bf16 v[32:47], a[248:251], v[156:159], v[32:47]
  buffer_load_dwordx4 a[200:203], v2, s[28:31], s73 offen offset:1024 sc1
  v_mfma_f32_32x32x16_bf16 v[48:63], a[252:255], v[152:155], v[48:63]
  v_pk_mul_f32 v[16:17], v[16:17], v[80:81]
  v_pk_mul_f32 v[18:19], v[18:19], v[82:83]
  v_pk_mul_f32 v[20:21], v[20:21], v[84:85]
  v_pk_mul_f32 v[22:23], v[22:23], v[86:87]
  v_pk_mul_f32 v[24:25], v[24:25], v[88:89]
  v_pk_mul_f32 v[26:27], v[26:27], v[90:91]
  v_pk_mul_f32 v[28:29], v[28:29], v[92:93]
  v_pk_mul_f32 v[30:31], v[30:31], v[94:95]
  v_mfma_f32_32x32x16_bf16 v[64:79], a[252:255], v[156:159], v[64:79]
  buffer_load_dwordx4 a[204:207], v2, s[28:31], s74 offen offset:1024 sc1
  v_pk_mul_f32 v[32:33], v[32:33], v[80:81]
  v_pk_mul_f32 v[34:35], v[34:35], v[82:83]
  v_pk_mul_f32 v[36:37], v[36:37], v[84:85]
  v_pk_mul_f32 v[38:39], v[38:39], v[86:87]
  v_pk_mul_f32 v[40:41], v[40:41], v[88:89]
  v_pk_mul_f32 v[42:43], v[42:43], v[90:91]
  v_pk_mul_f32 v[44:45], v[44:45], v[92:93]
  v_pk_mul_f32 v[46:47], v[46:47], v[94:95]
  s_waitcnt vmcnt(15)
  v_mfma_f32_32x32x16_bf16 v[16:31], a[144:147], a[56:59], v[16:31]
  v_pk_mul_f32 v[48:49], v[48:49], v[96:97]
  v_pk_mul_f32 v[50:51], v[50:51], v[98:99]
  v_pk_mul_f32 v[52:53], v[52:53], v[100:101]
  v_pk_mul_f32 v[54:55], v[54:55], v[102:103]
  v_pk_mul_f32 v[56:57], v[56:57], v[104:105]
  v_pk_mul_f32 v[58:59], v[58:59], v[106:107]
  v_pk_mul_f32 v[60:61], v[60:61], v[108:109]
  v_pk_mul_f32 v[62:63], v[62:63], v[110:111]
  v_mfma_f32_32x32x16_bf16 v[32:47], a[144:147], a[60:63], v[32:47]
  v_pk_mul_f32 v[64:65], v[64:65], v[96:97]
  v_pk_mul_f32 v[66:67], v[66:67], v[98:99]
  v_pk_mul_f32 v[68:69], v[68:69], v[100:101]
  v_pk_mul_f32 v[70:71], v[70:71], v[102:103]
  v_pk_mul_f32 v[72:73], v[72:73], v[104:105]
  v_pk_mul_f32 v[74:75], v[74:75], v[106:107]
  v_pk_mul_f32 v[76:77], v[76:77], v[108:109]
  v_pk_mul_f32 v[78:79], v[78:79], v[110:111]
  s_waitcnt vmcnt(14)
  v_mfma_f32_32x32x16_bf16 v[48:63], a[148:151], a[56:59], v[48:63]
  v_mfma_f32_32x32x16_bf16 v[64:79], a[148:151], a[60:63], v[64:79]
  s_waitcnt vmcnt(13)
  v_mfma_f32_32x32x16_bf16 v[16:31], a[152:155], a[64:67], v[16:31]
  ds_read_b64_tr_b16 v[144:145], v201 offset:8192
  ds_read_b64_tr_b16 v[146:147], v201 offset:9216
  v_mfma_f32_32x32x16_bf16 v[32:47], a[152:155], a[68:71], v[32:47]
  ds_read_b64_tr_b16 v[148:149], v202 offset:8192
  ds_read_b64_tr_b16 v[150:151], v202 offset:9216
  s_waitcnt vmcnt(12)
  v_mfma_f32_32x32x16_bf16 v[48:63], a[156:159], a[64:67], v[48:63]
  v_mfma_f32_32x32x16_bf16 v[64:79], a[156:159], a[68:71], v[64:79]
  s_waitcnt vmcnt(11) lgkmcnt(2)
  v_mfma_f32_32x32x16_bf16 v[16:31], a[160:163], v[144:147], v[16:31]
  ds_read_b64_tr_b16 v[152:153], v201 offset:45056
  ds_read_b64_tr_b16 v[154:155], v201 offset:46080
  s_waitcnt lgkmcnt(2)
  v_mfma_f32_32x32x16_bf16 v[32:47], a[160:163], v[148:151], v[32:47]
  ds_read_b64_tr_b16 v[156:157], v202 offset:45056
  ds_read_b64_tr_b16 v[158:159], v202 offset:46080
  s_waitcnt vmcnt(10)
  v_mfma_f32_32x32x16_bf16 v[48:63], a[164:167], v[144:147], v[48:63]
  v_mfma_f32_32x32x16_bf16 v[64:79], a[164:167], v[148:151], v[64:79]
  s_waitcnt vmcnt(9) lgkmcnt(2)
  v_mfma_f32_32x32x16_bf16 v[16:31], a[168:171], v[152:155], v[16:31]
  ds_read_b64_tr_b16 v[144:145], v201 offset:47104
  ds_read_b64_tr_b16 v[146:147], v201 offset:48128
  s_waitcnt lgkmcnt(2)
  v_mfma_f32_32x32x16_bf16 v[32:47], a[168:171], v[156:159], v[32:47]
  ds_read_b64_tr_b16 v[148:149], v202 offset:47104
  ds_read_b64_tr_b16 v[150:151], v202 offset:48128
  s_waitcnt vmcnt(8)
  v_mfma_f32_32x32x16_bf16 v[48:63], a[172:175], v[152:155], v[48:63]
  v_mfma_f32_32x32x16_bf16 v[64:79], a[172:175], v[156:159], v[64:79]
  s_waitcnt vmcnt(7) lgkmcnt(2)
  v_mfma_f32_32x32x16_bf16 v[16:31], a[176:179], v[144:147], v[16:31]
  ds_read_b64_tr_b16 v[152:153], v201 offset:49152
  ds_read_b64_tr_b16 v[154:155], v201 offset:50176
  s_waitcnt lgkmcnt(2)
  v_mfma_f32_32x32x16_bf16 v[32:47], a[176:179], v[148:151], v[32:47]
  ds_read_b64_tr_b16 v[156:157], v202 offset:49152
  ds_read_b64_tr_b16 v[158:159], v202 offset:50176
  s_waitcnt vmcnt(6)
  v_mfma_f32_32x32x16_bf16 v[48:63], a[180:183], v[144:147], v[48:63]
  v_mfma_f32_32x32x16_bf16 v[64:79], a[180:183], v[148:151], v[64:79]
  s_waitcnt vmcnt(5) lgkmcnt(2)
  v_mfma_f32_32x32x16_bf16 v[16:31], a[184:187], v[152:155], v[16:31]
  ds_read_b64_tr_b16 v[144:145], v201 offset:51200
  ds_read_b64_tr_b16 v[146:147], v201 offset:52224
  s_waitcnt lgkmcnt(2)
  v_mfma_f32_32x32x16_bf16 v[32:47], a[184:187], v[156:159], v[32:47]
  ds_read_b64_tr_b16 v[148:149], v202 offset:51200
  ds_read_b64_tr_b16 v[150:151], v202 offset:52224
  s_waitcnt vmcnt(4)
  v_mfma_f32_32x32x16_bf16 v[48:63], a[188:191], v[152:155], v[48:63]
  v_mfma_f32_32x32x16_bf16 v[64:79], a[188:191], v[156:159], v[64:79]
  s_waitcnt vmcnt(3) lgkmcnt(2)
  v_mfma_f32_32x32x16_bf16 v[16:31], a[192:195], v[144:147], v[16:31]
  ds_read_b64_tr_b16 v[152:153], v201 offset:53248
  ds_read_b64_tr_b16 v[154:155], v201 offset:54272
  s_waitcnt lgkmcnt(2)
  v_mfma_f32_32x32x16_bf16 v[32:47], a[192:195], v[148:151], v[32:47]
  ds_read_b64_tr_b16 v[156:157], v202 offset:53248
  ds_read_b64_tr_b16 v[158:159], v202 offset:54272
  s_waitcnt vmcnt(2)
  v_mfma_f32_32x32x16_bf16 v[48:63], a[196:199], v[144:147], v[48:63]
  v_mfma_f32_32x32x16_bf16 v[64:79], a[196:199], v[148:151], v[64:79]
  s_waitcnt vmcnt(1) lgkmcnt(2)
  v_mfma_f32_32x32x16_bf16 v[16:31], a[200:203], v[152:155], v[16:31]
  s_mov_b32 m0, s52
  s_waitcnt lgkmcnt(0)
  v_mfma_f32_32x32x16_bf16 v[32:47], a[200:203], v[156:159], v[32:47]
  s_waitcnt vmcnt(0)
  v_mfma_f32_32x32x16_bf16 v[48:63], a[204:207], v[152:155], v[48:63]
  ds_write_addtid_b32 v16 offset:0
  ds_write_addtid_b32 v17 offset:256
  ds_write_addtid_b32 v18 offset:512
  ds_write_addtid_b32 v19 offset:768
  ds_write_addtid_b32 v20 offset:1024
  ds_write_addtid_b32 v21 offset:1280
  ds_write_addtid_b32 v22 offset:1536
  v_mfma_f32_32x32x16_bf16 v[64:79], a[204:207], v[156:159], v[64:79]
  ds_write_addtid_b32 v23 offset:1792
  ds_write_addtid_b32 v24 offset:2048
  ds_write_addtid_b32 v25 offset:2304
  ds_write_addtid_b32 v26 offset:2560
  ds_write_addtid_b32 v27 offset:2816
  ds_write_addtid_b32 v28 offset:3072
  ds_write_addtid_b32 v29 offset:3328
  ds_write_addtid_b32 v30 offset:3584
  ds_write_addtid_b32 v31 offset:3840
  ds_write_addtid_b32 v32 offset:4096
  ds_write_addtid_b32 v33 offset:4352
  ds_write_addtid_b32 v34 offset:4608
  ds_write_addtid_b32 v35 offset:4864
  ds_write_addtid_b32 v36 offset:5120
  ds_write_addtid_b32 v37 offset:5376
  ds_write_addtid_b32 v38 offset:5632
  ds_write_addtid_b32 v39 offset:5888
  ds_write_addtid_b32 v40 offset:6144
  ds_write_addtid_b32 v41 offset:6400
  ds_write_addtid_b32 v42 offset:6656
  ds_write_addtid_b32 v43 offset:6912
  ds_write_addtid_b32 v44 offset:7168
  ds_write_addtid_b32 v45 offset:7424
  ds_write_addtid_b32 v46 offset:7680
  ds_write_addtid_b32 v47 offset:7936
  ds_write_addtid_b32 v48 offset:8192
  ds_write_addtid_b32 v49 offset:8448
  ds_write_addtid_b32 v50 offset:8704
  ds_write_addtid_b32 v51 offset:8960
  ds_write_addtid_b32 v52 offset:9216
  ds_write_addtid_b32 v53 offset:9472
  ds_write_addtid_b32 v54 offset:9728
  ds_write_addtid_b32 v55 offset:9984
  ds_write_addtid_b32 v56 offset:10240
  ds_write_addtid_b32 v57 offset:10496
  ds_write_addtid_b32 v58 offset:10752
  ds_write_addtid_b32 v59 offset:11008
  ds_write_addtid_b32 v60 offset:11264
  ds_write_addtid_b32 v61 offset:11520
  ds_write_addtid_b32 v62 offset:11776
  ds_write_addtid_b32 v63 offset:12032
  ds_write_addtid_b32 v64 offset:12288
  ds_write_addtid_b32 v65 offset:12544
  ds_write_addtid_b32 v66 offset:12800
  ds_write_addtid_b32 v67 offset:13056
  ds_write_addtid_b32 v68 offset:13312
  ds_write_addtid_b32 v69 offset:13568
  ds_write_addtid_b32 v70 offset:13824
  ds_write_addtid_b32 v71 offset:14080
  ds_write_addtid_b32 v72 offset:14336
  ds_write_addtid_b32 v73 offset:14592
  ds_write_addtid_b32 v74 offset:14848
  ds_write_addtid_b32 v75 offset:15104
  ds_write_addtid_b32 v76 offset:15360
  ds_write_addtid_b32 v77 offset:15616
  ds_write_addtid_b32 v78 offset:15872
  ds_write_addtid_b32 v79 offset:16128
  s_waitcnt lgkmcnt(0)
  s_barrier
  ds_read_b128 v[80:83], v210 offset:0
  ds_read_b128 v[84:87], v210 offset:16384
  ds_read_b128 v[88:91], v210 offset:32768
  ds_read_b128 v[92:95], v210 offset:49152
  ds_read_b128 v[96:99], v210 offset:4096
  ds_read_b128 v[100:103], v210 offset:20480
  ds_read_b128 v[104:107], v210 offset:36864
  ds_read_b128 v[108:111], v210 offset:53248
  ds_read_b128 v[112:115], v210 offset:1024
  ds_read_b128 v[116:119], v210 offset:17408
  ds_read_b128 v[120:123], v210 offset:33792
  ds_read_b128 v[124:127], v210 offset:50176
  ds_read_b128 v[128:131], v210 offset:5120
  ds_read_b128 v[132:135], v210 offset:21504
  ds_read_b128 v[136:139], v210 offset:37888
  ds_read_b128 v[140:143], v210 offset:54272
  s_waitcnt lgkmcnt(14)
  v_pk_add_f32 v[80:81], v[80:81], v[84:85]
  s_waitcnt lgkmcnt(12)
  v_pk_add_f32 v[88:89], v[88:89], v[92:93]
  v_pk_add_f32 v[82:83], v[82:83], v[86:87]
  v_pk_add_f32 v[90:91], v[90:91], v[94:95]
  v_pk_add_f32 v[80:81], v[80:81], v[88:89]
  v_pk_add_f32 v[82:83], v[82:83], v[90:91]
  v_cvt_pk_bf16_f32 v80, v80, v81
  v_cvt_pk_bf16_f32 v81, v82, v83
  buffer_store_dwordx2 v[80:81], v211, s[32:35], s98 offen offset:0
  s_waitcnt lgkmcnt(10)
  v_pk_add_f32 v[96:97], v[96:97], v[100:101]
  s_waitcnt lgkmcnt(8)
  v_pk_add_f32 v[104:105], v[104:105], v[108:109]
  v_pk_add_f32 v[98:99], v[98:99], v[102:103]
  v_pk_add_f32 v[106:107], v[106:107], v[110:111]
  v_pk_add_f32 v[96:97], v[96:97], v[104:105]
  v_pk_add_f32 v[98:99], v[98:99], v[106:107]
  v_cvt_pk_bf16_f32 v96, v96, v97
  v_cvt_pk_bf16_f32 v97, v98, v99
  buffer_store_dwordx2 v[96:97], v211, s[32:35], s98 offen offset:64
  s_waitcnt lgkmcnt(6)
  v_pk_add_f32 v[112:113], v[112:113], v[116:117]
  s_waitcnt lgkmcnt(4)
  v_pk_add_f32 v[120:121], v[120:121], v[124:125]
  v_pk_add_f32 v[114:115], v[114:115], v[118:119]
  v_pk_add_f32 v[122:123], v[122:123], v[126:127]
  v_pk_add_f32 v[112:113], v[112:113], v[120:121]
  v_pk_add_f32 v[114:115], v[114:115], v[122:123]
  v_cvt_pk_bf16_f32 v112, v112, v113
  v_cvt_pk_bf16_f32 v113, v114, v115
  buffer_store_dwordx2 v[112:113], v211, s[32:35], s99 offen offset:0
  s_waitcnt lgkmcnt(2)
  v_pk_add_f32 v[128:129], v[128:129], v[132:133]
  s_waitcnt lgkmcnt(0)
  v_pk_add_f32 v[136:137], v[136:137], v[140:141]
  v_pk_add_f32 v[130:131], v[130:131], v[134:135]
  v_pk_add_f32 v[138:139], v[138:139], v[142:143]
  v_pk_add_f32 v[128:129], v[128:129], v[136:137]
  v_pk_add_f32 v[130:131], v[130:131], v[138:139]
  v_cvt_pk_bf16_f32 v128, v128, v129
  v_cvt_pk_bf16_f32 v129, v130, v131
  buffer_store_dwordx2 v[128:129], v211, s[32:35], s99 offen offset:64
  s_endpgm
  .p2align 7
L_att_rest:
  s_mov_b64 s[24:25], s[14:15]
  s_mov_b64 s[32:33], s[18:19]
  s_mov_b64 s[28:29], s[22:23]
  s_lshr_b32 s37, s36, 1
  s_and_b32 s38, s36, 1
  v_and_b32 v10, 31, v1
  v_lshrrev_b32 v11, 5, v1
  v_bfe_u32 v12, v1, 1, 3
  v_xor_b32 v12, v12, v11
  v_lshlrev_b32 v12, 4, v12
  v_lshl_add_u32 v12, v10, 7, v12
  s_add_u32 s66, s45, 73728
  s_xor_b32 s67, s45, 4096
  s_add_u32 s67, s67, 73728
  v_xor_b32 v13, 0, v12
  v_add_u32 v176, s66, v13
  v_add_u32 v180, s67, v13
  v_xor_b32 v13, 32, v12
  v_add_u32 v177, s66, v13
  v_add_u32 v181, s67, v13
  v_xor_b32 v13, 64, v12
  v_add_u32 v178, s66, v13
  v_add_u32 v182, s67, v13
  v_xor_b32 v13, 96, v12
  v_add_u32 v179, s66, v13
  v_add_u32 v183, s67, v13
  v_bfe_u32 v13, v1, 2, 2
  v_bfe_u32 v14, v1, 4, 1
  v_lshlrev_b32 v14, 5, v14
  v_and_b32 v15, 3, v1
  v_lshl_add_u32 v14, v15, 3, v14
  v_lshl_add_u32 v15, v11, 3, v13
  v_lshl_add_u32 v15, v15, 7, v14
  v_lshrrev_b32 v9, 1, v13
  v_xor_b32 v9, s38, v9
  v_lshl_add_u32 v15, v9, 6, v15
  v_add_u32 v184, 90112, v15
  v_lshrrev_b32 v9, 2, v1
  v_xor_b32 v9, v9, v5
  v_and_b32 v9, 1, v9
  v_lshlrev_b32 v9, 10, v9
  v_lshl_add_u32 v9, v11, 4, v9
  v_add_u32 v185, 114688, v9
  v_mov_b32 v216, 0
  v_mov_b32 v217, 0
  v_mov_b32 v218, 0
  v_mov_b32 v219, 0
  v_add_u32 v9, 115712, v2
  ds_write_b128 v9, v[216:219]
  s_mov_b32 s30, 17825792
  s_mov_b32 s31, 0x20000
  s_mov_b32 s26, 1835008
  s_mov_b32 s27, 0x20000
  s_mov_b32 s10, 524288
  s_mov_b32 s11, 0x20000
  s_mov_b32 s22, 256
  s_mov_b32 s23, 0x20000
  s_mov_b32 s18, 1024
  s_mov_b32 s19, 0x20000
  v_mov_b32 v3, 0
  s_lshl_b32 s66, s47, 7
  v_add_u32 v9, s66, v2
  v_and_b32 v9, 1023, v9
  s_mov_b32 m0, 114688
  s_nop 0
  buffer_load_dwordx4 v9, s[16:19], 0 offen lds
  s_add_u32 m0, s45, 118784
  s_nop 0
  buffer_load_dwordx4 v186, s[4:7], s43 offen offset:0 lds
  buffer_load_dwordx4 v187, s[4:7], s43 offen offset:1024 lds
  s_cmp_eq_u32 s47, 6
  s_cselect_b32 s49, -7, 1
  buffer_load_dwordx4 v188, s[4:7], s43 offen offset:2048 lds
  s_lshl_b32 s87, s49, 7
  buffer_load_dwordx4 v189, s[4:7], s43 offen offset:3072 lds
  s_add_u32 s43, s43, s87
  s_add_u32 m0, s46, 135168
  s_nop 0
  buffer_load_dwordx4 v190, s[88:91], s44 offen offset:0 lds
  buffer_load_dwordx4 v191, s[88:91], s44 offen offset:1024 lds
  s_mul_i32 s49, s49, 196608
  buffer_load_dwordx4 v192, s[88:91], s44 offen offset:2048 lds
  buffer_load_dwordx4 v193, s[88:91], s44 offen offset:3072 lds
  s_add_u32 m0, s46, 139264
  s_nop 0
  buffer_load_dwordx4 v194, s[88:91], s44 offen offset:0 lds
  buffer_load_dwordx4 v195, s[88:91], s44 offen offset:1024 lds
  s_add_u32 s44, s44, s49
  s_lshr_b32 s68, s2, 3
  s_and_b32 s69, s2, 3
  s_lshl2_add_u32 s68, s68, s69
  s_lshl2_add_u32 s68, s68, s36
  s_mul_i32 s69, s68, 3584
  v_lshl_add_u32 v249, v1, 7, s69
  s_lshl_b32 s68, s68, 10
  v_lshl_add_u32 v250, v1, 7, s68
  s_waitcnt lgkmcnt(0)
  s_waitcnt vmcnt(10)
  s_barrier
  ds_read_b128 v[128:131], v176
  ds_read_b64_tr_b16 v[144:145], v184 offset:0
  ds_read_b64_tr_b16 v[146:147], v184 offset:512
  ds_read_b128 v[136:139], v180
  ds_read_b64_tr_b16 v[148:149], v184 offset:2048
  ds_read_b64_tr_b16 v[150:151], v184 offset:2560
  ds_read_b64_tr_b16 v[152:153], v184 offset:4096
  ds_read_b64_tr_b16 v[154:155], v184 offset:4608
  ds_read_b128 v[156:159], v185 offset:0
  s_waitcnt lgkmcnt(3)
  v_mfma_f32_32x32x16_bf16 v[16:31], v[128:131], v[144:147], 0
  ds_read_b128 v[132:135], v177
  ds_read_b64_tr_b16 v[160:161], v184 offset:6144
  v_add_u32 v176, 0xb000, v176
  v_mfma_f32_32x32x16_bf16 v[32:47], v[136:139], v[144:147], 0
  s_add_u32 m0, s45, 0
  ds_read_b64_tr_b16 v[162:163], v184 offset:6656
  ds_read_b128 v[140:143], v181
  buffer_load_dwordx4 v186, s[4:7], s43 offen offset:0 lds
  v_mfma_f32_32x32x16_bf16 v[48:63], v[128:131], v[148:151], 0
  ds_read_b64_tr_b16 v[164:165], v184 offset:8192
  ds_read_b64_tr_b16 v[166:167], v184 offset:8704
  v_add_u32 v180, 0xb000, v180
  v_mfma_f32_32x32x16_bf16 v[64:79], v[136:139], v[148:151], 0
  ds_read_b64_tr_b16 v[168:169], v184 offset:10240
  ds_read_b64_tr_b16 v[170:171], v184 offset:10752
  buffer_load_dwordx4 v187, s[4:7], s43 offen offset:1024 lds
  s_cmp_eq_u32 s47, 5
  s_cselect_b32 s49, -7, 1
  s_waitcnt lgkmcnt(8)
  v_mfma_f32_32x32x16_bf16 v[80:95], v[152:155], v[128:131], 0
  ds_read_b128 v[172:175], v185 offset:32
  v_add_u32 v177, 0xb000, v177
  v_add_u32 v181, 0xb000, v181
  v_mfma_f32_32x32x16_bf16 v[96:111], v[152:155], v[136:139], 0
  buffer_load_dwordx4 v188, s[4:7], s43 offen offset:2048 lds
  s_lshl_b32 s87, s49, 7
  v_mfma_f32_16x16x32_bf16 v[112:115], v[156:159], v[128:131], 0
  buffer_load_dwordx4 v189, s[4:7], s43 offen offset:3072 lds
  s_add_u32 s43, s43, s87
  s_waitcnt lgkmcnt(3)
  v_mfma_f32_32x32x16_bf16 v[16:31], v[132:135], v[160:163], v[16:31]
  ds_read_b128 v[128:131], v178
  ds_read_b64_tr_b16 v[144:145], v184 offset:12288
  s_mov_b32 s62, 0xffff0000
  s_mov_b32 s63, 0xffff0000
  v_mfma_f32_32x32x16_bf16 v[32:47], v[140:143], v[160:163], v[32:47]
  s_add_u32 m0, s46, 16384
  ds_read_b64_tr_b16 v[146:147], v184 offset:12800
  ds_read_b128 v[136:139], v182
  buffer_load_dwordx4 v190, s[88:91], s44 offen offset:0 lds
  v_mfma_f32_32x32x16_bf16 v[48:63], v[132:135], v[164:167], v[48:63]
  ds_read_b64_tr_b16 v[148:149], v184 offset:14336
  ds_read_b64_tr_b16 v[150:151], v184 offset:14848
  s_mov_b32 s56, 0xbfb8aa3b
  s_mov_b32 s57, 0xbfb8aa3b
  v_mfma_f32_32x32x16_bf16 v[64:79], v[140:143], v[164:167], v[64:79]
  ds_read_b64_tr_b16 v[152:153], v184 offset:16384
  ds_read_b64_tr_b16 v[154:155], v184 offset:16896
  buffer_load_dwordx4 v191, s[88:91], s44 offen offset:1024 lds
  s_mul_i32 s49, s49, 196608
  s_waitcnt lgkmcnt(8)
  v_mfma_f32_32x32x16_bf16 v[80:95], v[168:171], v[132:135], v[80:95]
  ds_read_b128 v[156:159], v185 offset:64
  v_add_u32 v178, 0xb000, v178
  v_add_u32 v182, 0xb000, v182
  s_mov_b32 s58, 0x3f800000
  v_mfma_f32_32x32x16_bf16 v[96:111], v[168:171], v[140:143], v[96:111]
  buffer_load_dwordx4 v192, s[88:91], s44 offen offset:2048 lds
  s_mov_b32 s59, 0x3f800000
  s_mov_b32 s60, 0x358637bd
  s_mov_b32 s61, 0x358637bd
  v_mfma_f32_16x16x32_bf16 v[112:115], v[172:175], v[132:135], v[112:115]
  buffer_load_dwordx4 v193, s[88:91], s44 offen offset:3072 lds
  s_mov_b32 s64, 0x3fb8aa3b
  s_waitcnt lgkmcnt(3)
  v_mfma_f32_32x32x16_bf16 v[16:31], v[128:131], v[144:147], v[16:31]
  ds_read_b128 v[132:135], v179
  ds_read_b64_tr_b16 v[160:161], v184 offset:18432
  s_mov_b32 s65, 0x3fb8aa3b
  s_mov_b32 s86, 0x3f80
  v_mfma_f32_32x32x16_bf16 v[32:47], v[136:139], v[144:147], v[32:47]
  s_add_u32 m0, s46, 20480
  ds_read_b64_tr_b16 v[162:163], v184 offset:18944
  ds_read_b128 v[140:143], v183
  buffer_load_dwordx4 v194, s[88:91], s44 offen offset:0 lds
  v_mfma_f32_32x32x16_bf16 v[48:63], v[128:131], v[148:151], v[48:63]
  ds_read_b64_tr_b16 v[164:165], v184 offset:20480
  ds_read_b64_tr_b16 v[166:167], v184 offset:20992
  s_mov_b32 s75, 524288
  s_mov_b32 s34, 2097152
  v_mfma_f32_32x32x16_bf16 v[64:79], v[136:139], v[148:151], v[64:79]
  ds_read_b64_tr_b16 v[168:169], v184 offset:22528
  ds_read_b64_tr_b16 v[170:171], v184 offset:23040
  buffer_load_dwordx4 v195, s[88:91], s44 offen offset:1024 lds
  s_add_u32 s44, s44, s49
  s_waitcnt lgkmcnt(8)
  v_mfma_f32_32x32x16_bf16 v[80:95], v[152:155], v[128:131], v[80:95]
  ds_read_b128 v[172:175], v185 offset:96
  v_add_u32 v179, 0xb000, v179
  v_add_u32 v183, 0xb000, v183
  s_mov_b32 s35, 0x20000
  v_mfma_f32_32x32x16_bf16 v[96:111], v[152:155], v[136:139], v[96:111]
  v_add_u32 v184, 0xb000, v184
  s_bfe_u32 s41, s2, 0x20001
  s_lshr_b32 s66, s2, 5
  s_lshl3_add_u32 s41, s41, s66
  v_mfma_f32_16x16x32_bf16 v[112:115], v[156:159], v[128:131], v[112:115]
  v_add_u32 v185, 128, v185
  s_and_b32 s42, s2, 1
  s_waitcnt lgkmcnt(0)
  v_mfma_f32_32x32x16_bf16 v[16:31], v[132:135], v[160:163], v[16:31]
  s_bfe_u32 s66, s2, 0x20003
  s_lshl2_add_u32 s42, s42, s66
  v_lshl_add_u32 v197, v4, 10, v8
  v_add_u32 v198, 7168, v197
  v_mfma_f32_32x32x16_bf16 v[32:47], v[140:143], v[160:163], v[32:47]
  s_waitcnt vmcnt(10)
  s_barrier
  ds_read_b128 v[128:131], v176
  ds_read_b64_tr_b16 v[144:145], v184 offset:0
  s_mul_i32 s100, s36, 458752
  v_mfma_f32_32x32x16_bf16 v[48:63], v[132:135], v[164:167], v[48:63]
  ds_read_b64_tr_b16 v[146:147], v184 offset:512
  ds_read_b128 v[136:139], v180
  s_lshl_b32 s66, s42, 7
  s_add_u32 s100, s100, s66
  v_mfma_f32_32x32x16_bf16 v[64:79], v[140:143], v[164:167], v[64:79]
  ds_read_b64_tr_b16 v[148:149], v184 offset:2048
  ds_read_b64_tr_b16 v[150:151], v184 offset:2560
  s_lshl_b32 s54, s36, 17
  s_add_u32 s54, s54, s66
  v_mfma_f32_32x32x16_bf16 v[80:95], v[168:171], v[132:135], v[80:95]
  ds_read_b64_tr_b16 v[152:153], v184 offset:4096
  ds_read_b64_tr_b16 v[154:155], v184 offset:4608
  s_add_u32 s48, s41, s42
  s_mul_i32 s48, s48, -1
  v_mfma_f32_32x32x16_bf16 v[96:111], v[168:171], v[140:143], v[96:111]
  ds_read_b128 v[156:159], v185 offset:0
  s_and_b32 s48, s48, 3
  s_lshl_b32 s68, s48, 3
  s_mov_b32 s66, 0x180e0a00
  v_mfma_f32_16x16x32_bf16 v[112:115], v[172:175], v[132:135], v[112:115]
  s_mov_b32 s67, 0x180e0a00
  s_lshr_b64 s[66:67], s[66:67], s68
  s_waitcnt lgkmcnt(3)
  v_mfma_f32_32x32x16_bf16 v[16:31], v[128:131], v[144:147], v[16:31]
  ds_read_b128 v[132:135], v177
  ds_read_b64_tr_b16 v[160:161], v184 offset:6144
  v_add_u32 v176, 0xfffe3000, v176
  s_mov_b32 s48, s66
  v_mfma_f32_32x32x16_bf16 v[32:47], v[136:139], v[144:147], v[32:47]
  s_add_u32 m0, s45, 73728
  ds_read_b64_tr_b16 v[162:163], v184 offset:6656
  ds_read_b128 v[140:143], v181
  buffer_load_dwordx4 v186, s[4:7], s43 offen offset:0 lds
  v_mfma_f32_32x32x16_bf16 v[48:63], v[128:131], v[148:151], v[48:63]
  ds_read_b64_tr_b16 v[164:165], v184 offset:8192
  ds_read_b64_tr_b16 v[166:167], v184 offset:8704
  v_add_u32 v180, 0xfffe3000, v180
  s_mov_b32 s66, 0x15120704
  v_mfma_f32_32x32x16_bf16 v[64:79], v[136:139], v[148:151], v[64:79]
  ds_read_b64_tr_b16 v[168:169], v184 offset:10240
  ds_read_b64_tr_b16 v[170:171], v184 offset:10752
  buffer_load_dwordx4 v187, s[4:7], s43 offen offset:1024 lds
  s_cmp_eq_u32 s47, 4
  s_cselect_b32 s49, -7, 1
  s_waitcnt lgkmcnt(8)
  v_mfma_f32_32x32x16_bf16 v[80:95], v[152:155], v[128:131], v[80:95]
  ds_read_b128 v[172:175], v185 offset:32
  v_add_u32 v177, 0xfffe3000, v177
  v_add_u32 v181, 0xfffe3000, v181
  s_mov_b32 s67, 0x15120704
  v_mfma_f32_32x32x16_bf16 v[96:111], v[152:155], v[136:139], v[96:111]
  buffer_load_dwordx4 v188, s[4:7], s43 offen offset:2048 lds
  s_lshl_b32 s87, s49, 7
  s_lshr_b64 s[66:67], s[66:67], s68
  s_mov_b32 s0, s66
  v_mfma_f32_16x16x32_bf16 v[112:115], v[156:159], v[128:131], v[112:115]
  buffer_load_dwordx4 v189, s[4:7], s43 offen offset:3072 lds
  s_add_u32 s43, s43, s87
  s_waitcnt lgkmcnt(3)
  v_mfma_f32_32x32x16_bf16 v[16:31], v[132:135], v[160:163], v[16:31]
  ds_read_b128 v[128:131], v178
  ds_read_b64_tr_b16 v[144:145], v184 offset:12288
  s_mov_b32 s66, 0x6040200
  s_mov_b32 s67, 0x6040200
  v_mfma_f32_32x32x16_bf16 v[32:47], v[140:143], v[160:163], v[32:47]
  s_add_u32 m0, s46, 90112
  ds_read_b64_tr_b16 v[146:147], v184 offset:12800
  ds_read_b128 v[136:139], v182
  buffer_load_dwordx4 v190, s[88:91], s44 offen offset:0 lds
  v_mfma_f32_32x32x16_bf16 v[48:63], v[132:135], v[164:167], v[48:63]
  ds_read_b64_tr_b16 v[148:149], v184 offset:14336
  ds_read_b64_tr_b16 v[150:151], v184 offset:14848
  s_lshr_b64 s[66:67], s[66:67], s68
  s_mov_b32 s1, s66
  v_mfma_f32_32x32x16_bf16 v[64:79], v[140:143], v[164:167], v[64:79]
  ds_read_b64_tr_b16 v[152:153], v184 offset:16384
  ds_read_b64_tr_b16 v[154:155], v184 offset:16896
  buffer_load_dwordx4 v191, s[88:91], s44 offen offset:1024 lds
  s_mul_i32 s49, s49, 196608
  s_waitcnt lgkmcnt(8)
  v_mfma_f32_32x32x16_bf16 v[80:95], v[168:171], v[132:135], v[80:95]
  ds_read_b128 v[156:159], v185 offset:64
  v_add_u32 v178, 0xfffe3000, v178
  v_add_u32 v182, 0xfffe3000, v182
  s_lshl_b32 s52, s36, 14
  v_mfma_f32_32x32x16_bf16 v[96:111], v[168:171], v[140:143], v[96:111]
  buffer_load_dwordx4 v192, s[88:91], s44 offen offset:2048 lds
  s_mul_i32 s53, s36, 10240
  s_add_u32 s53, s53, 73728
  v_lshl_add_u32 v15, v11, 2, v13
  v_mfma_f32_16x16x32_bf16 v[112:115], v[172:175], v[132:135], v[112:115]
  buffer_load_dwordx4 v193, s[88:91], s44 offen offset:3072 lds
  v_lshl_add_u32 v15, v15, 7, v14
  s_waitcnt lgkmcnt(3)
  v_mfma_f32_32x32x16_bf16 v[16:31], v[128:131], v[144:147], v[16:31]
  ds_read_b128 v[132:135], v179
  ds_read_b64_tr_b16 v[160:161], v184 offset:18432
  v_lshrrev_b32 v9, 1, v13
  v_lshl_add_u32 v15, v9, 6, v15
  v_mfma_f32_32x32x16_bf16 v[32:47], v[136:139], v[144:147], v[32:47]
  s_add_u32 m0, s46, 94208
  ds_read_b64_tr_b16 v[162:163], v184 offset:18944
  ds_read_b128 v[140:143], v183
  buffer_load_dwordx4 v194, s[88:91], s44 offen offset:0 lds
  v_mfma_f32_32x32x16_bf16 v[48:63], v[128:131], v[148:151], v[48:63]
  ds_read_b64_tr_b16 v[164:165], v184 offset:20480
  ds_read_b64_tr_b16 v[166:167], v184 offset:20992
  v_add_u32 v199, s52, v15
  v_add_u32 v201, s53, v15
  v_mfma_f32_32x32x16_bf16 v[64:79], v[136:139], v[148:151], v[64:79]
  ds_read_b64_tr_b16 v[168:169], v184 offset:22528
  ds_read_b64_tr_b16 v[170:171], v184 offset:23040
  buffer_load_dwordx4 v195, s[88:91], s44 offen offset:1024 lds
  s_add_u32 s44, s44, s49
  s_waitcnt lgkmcnt(8)
  v_mfma_f32_32x32x16_bf16 v[80:95], v[152:155], v[128:131], v[80:95]
  ds_read_b128 v[172:175], v185 offset:96
  v_add_u32 v179, 0xfffe3000, v179
  v_add_u32 v183, 0xfffe3000, v183
  v_xor_b32 v15, 64, v15
  v_mfma_f32_32x32x16_bf16 v[96:111], v[152:155], v[136:139], v[96:111]
  v_add_u32 v184, 0xfffe3000, v184
  v_add_u32 v200, s52, v15
  v_add_u32 v202, s53, v15
  s_lshl1_add_u32 s66, s39, s37
  v_mfma_f32_16x16x32_bf16 v[112:115], v[156:159], v[128:131], v[112:115]
  v_add_u32 v185, 128, v185
  s_lshl3_add_u32 s66, s66, s40
  s_waitcnt lgkmcnt(0)
  v_mfma_f32_32x32x16_bf16 v[16:31], v[132:135], v[160:163], v[16:31]
  s_lshl1_add_u32 s66, s66, s38
  s_lshl_b32 s66, s66, 7
  s_add_u32 s93, s66, 131072
  s_lshl2_add_u32 s67, s39, s36
  v_mfma_f32_32x32x16_bf16 v[32:47], v[140:143], v[160:163], v[32:47]
  s_waitcnt vmcnt(10)
  s_barrier
  ds_read_b128 v[128:131], v176
  ds_read_b64_tr_b16 v[144:145], v184 offset:0
  s_xor_b32 s68, s67, 1
  v_mfma_f32_32x32x16_bf16 v[48:63], v[132:135], v[164:167], v[48:63]
  ds_read_b64_tr_b16 v[146:147], v184 offset:512
  ds_read_b128 v[136:139], v180
  s_mul_i32 s67, s67, 147456
  s_mul_i32 s68, s68, 147456
  v_mfma_f32_32x32x16_bf16 v[64:79], v[140:143], v[164:167], v[64:79]
  ds_read_b64_tr_b16 v[148:149], v184 offset:2048
  ds_read_b64_tr_b16 v[150:151], v184 offset:2560
  s_lshl1_add_u32 s66, s40, s38
  s_lshl_b32 s69, s66, 11
  v_mfma_f32_32x32x16_bf16 v[80:95], v[168:171], v[132:135], v[80:95]
  ds_read_b64_tr_b16 v[152:153], v184 offset:4096
  ds_read_b64_tr_b16 v[154:155], v184 offset:4608
  s_add_u32 s69, s69, 2211840
  s_add_u32 s70, s67, s69
  v_mfma_f32_32x32x16_bf16 v[96:111], v[168:171], v[140:143], v[96:111]
  ds_read_b128 v[156:159], v185 offset:0
  s_bitcmp0_b32 s2, 2
  s_cselect_b64 exec, 0xfffffff, 0
  buffer_load_dword v253, v249, s[24:27], 0 offen
  s_bitcmp0_b32 s2, 2
  s_cselect_b64 exec, 0xff, 0
  buffer_load_dword v254, v250, s[8:11], 0 offen
  s_mov_b64 exec, -1
  v_mfma_f32_16x16x32_bf16 v[112:115], v[172:175], v[132:135], v[112:115]
  s_add_u32 s71, s68, s69
  s_lshl_b32 s66, s66, 13
  s_waitcnt lgkmcnt(3)
  v_mfma_f32_32x32x16_bf16 v[16:31], v[128:131], v[144:147], v[16:31]
  ds_read_b128 v[132:135], v177
  ds_read_b64_tr_b16 v[160:161], v184 offset:6144
  v_add_u32 v176, 0x12000, v176
  s_lshl1_add_u32 s67, s39, s37
  v_mfma_f32_32x32x16_bf16 v[32:47], v[136:139], v[144:147], v[32:47]
  s_add_u32 m0, s45, 118784
  ds_read_b64_tr_b16 v[162:163], v184 offset:6656
  ds_read_b128 v[140:143], v181
  buffer_load_dwordx4 v186, s[4:7], s43 offen offset:0 lds
  v_mfma_f32_32x32x16_bf16 v[48:63], v[128:131], v[148:151], v[48:63]
  ds_read_b64_tr_b16 v[164:165], v184 offset:8192
  ds_read_b64_tr_b16 v[166:167], v184 offset:8704
  v_add_u32 v180, 0x12000, v180
  s_lshl_b32 s67, s67, 8
  v_mfma_f32_32x32x16_bf16 v[64:79], v[136:139], v[148:151], v[64:79]
  ds_read_b64_tr_b16 v[168:169], v184 offset:10240
  ds_read_b64_tr_b16 v[170:171], v184 offset:10752
  buffer_load_dwordx4 v187, s[4:7], s43 offen offset:1024 lds
  s_cmp_eq_u32 s47, 3
  s_cselect_b32 s49, -7, 1
  s_waitcnt lgkmcnt(8)
  v_mfma_f32_32x32x16_bf16 v[80:95], v[152:155], v[128:131], v[80:95]
  ds_read_b128 v[172:175], v185 offset:32
  v_add_u32 v177, 0x12000, v177
  v_add_u32 v181, 0x12000, v181
  s_add_u32 s66, s66, s67
  v_mfma_f32_32x32x16_bf16 v[96:111], v[152:155], v[136:139], v[96:111]
  buffer_load_dwordx4 v188, s[4:7], s43 offen offset:2048 lds
  s_lshl_b32 s87, s49, 7
  s_add_u32 s72, s66, 262144
  v_and_b32 v12, 15, v1
  v_mfma_f32_16x16x32_bf16 v[112:115], v[156:159], v[128:131], v[112:115]
  buffer_load_dwordx4 v189, s[4:7], s43 offen offset:3072 lds
  s_add_u32 s43, s43, s87
  s_waitcnt lgkmcnt(3)
  v_mfma_f32_32x32x16_bf16 v[16:31], v[132:135], v[160:163], v[16:31]
  ds_read_b128 v[128:131], v178
  ds_read_b64_tr_b16 v[144:145], v184 offset:12288
  v_lshlrev_b32 v13, 8, v11
  v_lshl_add_u32 v9, v12, 4, v13
  v_mfma_f32_32x32x16_bf16 v[32:47], v[140:143], v[160:163], v[32:47]
  s_add_u32 m0, s46, 135168
  ds_read_b64_tr_b16 v[146:147], v184 offset:12800
  ds_read_b128 v[136:139], v182
  buffer_load_dwordx4 v190, s[88:91], s44 offen offset:0 lds
  v_mfma_f32_32x32x16_bf16 v[48:63], v[132:135], v[164:167], v[48:63]
  ds_read_b64_tr_b16 v[148:149], v184 offset:14336
  ds_read_b64_tr_b16 v[150:151], v184 offset:14848
  s_lshl_b32 s66, s36, 11
  s_add_u32 s66, s66, 65536
  v_mfma_f32_32x32x16_bf16 v[64:79], v[140:143], v[164:167], v[64:79]
  ds_read_b64_tr_b16 v[152:153], v184 offset:16384
  ds_read_b64_tr_b16 v[154:155], v184 offset:16896
  buffer_load_dwordx4 v191, s[88:91], s44 offen offset:1024 lds
  s_mul_i32 s49, s49, 196608
  s_waitcnt lgkmcnt(8)
  v_mfma_f32_32x32x16_bf16 v[80:95], v[168:171], v[132:135], v[80:95]
  ds_read_b128 v[156:159], v185 offset:64
  v_add_u32 v178, 0x12000, v178
  v_add_u32 v182, 0x12000, v182
  v_add_u32 v13, s66, v9
  v_mfma_f32_32x32x16_bf16 v[96:111], v[168:171], v[140:143], v[96:111]
  buffer_load_dwordx4 v192, s[88:91], s44 offen offset:2048 lds
  s_lshl_b32 s66, s36, 6
  s_add_u32 s66, s66, 159744
  v_lshl_add_u32 v14, v11, 4, s66
  v_mfma_f32_16x16x32_bf16 v[112:115], v[172:175], v[132:135], v[112:115]
  buffer_load_dwordx4 v193, s[88:91], s44 offen offset:3072 lds
  v_cndmask_b32 v116, v13, v14, s[62:63]
  s_waitcnt lgkmcnt(3)
  v_mfma_f32_32x32x16_bf16 v[16:31], v[128:131], v[144:147], v[16:31]
  ds_read_b128 v[132:135], v179
  ds_read_b64_tr_b16 v[160:161], v184 offset:18432
  v_add_u32 v13, 1024, v13
  v_add_u32 v14, 32, v14
  v_mfma_f32_32x32x16_bf16 v[32:47], v[136:139], v[144:147], v[32:47]
  s_add_u32 m0, s46, 139264
  ds_read_b64_tr_b16 v[162:163], v184 offset:18944
  ds_read_b128 v[140:143], v183
  buffer_load_dwordx4 v194, s[88:91], s44 offen offset:0 lds
  v_mfma_f32_32x32x16_bf16 v[48:63], v[128:131], v[148:151], v[48:63]
  ds_read_b64_tr_b16 v[164:165], v184 offset:20480
  ds_read_b64_tr_b16 v[166:167], v184 offset:20992
  v_cndmask_b32 v117, v14, v13, s[62:63]
  s_lshl_b32 s66, s36, 7
  v_mfma_f32_32x32x16_bf16 v[64:79], v[136:139], v[148:151], v[64:79]
  ds_read_b64_tr_b16 v[168:169], v184 offset:22528
  ds_read_b64_tr_b16 v[170:171], v184 offset:23040
  buffer_load_dwordx4 v195, s[88:91], s44 offen offset:1024 lds
  s_add_u32 s44, s44, s49
  s_waitcnt lgkmcnt(8)
  v_mfma_f32_32x32x16_bf16 v[80:95], v[152:155], v[128:131], v[80:95]
  ds_read_b128 v[172:175], v185 offset:96
  v_add_u32 v179, 0x12000, v179
  v_add_u32 v183, 0x12000, v183
  s_add_u32 s66, s66, 160768
  v_mfma_f32_32x32x16_bf16 v[96:111], v[152:155], v[136:139], v[96:111]
  v_add_u32 v184, 0x12000, v184
  v_lshl_add_u32 v118, v10, 2, s66
  v_xor_b32 v119, 128, v118
  s_lshl1_add_u32 s67, s38, s37
  v_mfma_f32_16x16x32_bf16 v[112:115], v[156:159], v[128:131], v[112:115]
  v_add_u32 v185, 128, v185
  s_lshl_b32 s66, s67, 10
  s_waitcnt lgkmcnt(0)
  v_mfma_f32_32x32x16_bf16 v[16:31], v[132:135], v[160:163], v[16:31]
  s_add_u32 s66, s66, 65536
  v_add_u32 v120, s66, v2
  s_lshl_b32 s66, s67, 5
  s_add_u32 s66, s66, 159744
  v_mfma_f32_32x32x16_bf16 v[32:47], v[140:143], v[160:163], v[32:47]
  s_waitcnt vmcnt(12)
  s_barrier
  ds_read_b128 v[128:131], v176
  ds_read_b64_tr_b16 v[144:145], v184 offset:0
  v_bfe_u32 v15, v1, 3, 1
  v_mfma_f32_32x32x16_bf16 v[48:63], v[132:135], v[164:167], v[48:63]
  ds_read_b64_tr_b16 v[146:147], v184 offset:512
  ds_read_b128 v[136:139], v180
  v_lshlrev_b32 v13, 9, v15
  v_lshl_add_u32 v13, v6, 2, v13
  v_mfma_f32_32x32x16_bf16 v[64:79], v[140:143], v[164:167], v[64:79]
  ds_read_b64_tr_b16 v[148:149], v184 offset:2048
  ds_read_b64_tr_b16 v[150:151], v184 offset:2560
  v_add_u32 v121, s66, v13
  s_lshl2_add_u32 s68, s40, s67
  v_mfma_f32_32x32x16_bf16 v[80:95], v[168:171], v[132:135], v[80:95]
  ds_read_b64_tr_b16 v[152:153], v184 offset:4096
  ds_read_b64_tr_b16 v[154:155], v184 offset:4608
  s_mul_i32 s3, s68, 12288
  s_add_u32 s3, s3, 524288
  v_mfma_f32_32x32x16_bf16 v[96:111], v[168:171], v[140:143], v[96:111]
  ds_read_b128 v[156:159], v185 offset:0
  s_add_u32 s101, s3, 6144
  s_mul_i32 s92, s39, 768
  s_add_u32 s92, s92, s3
  v_mfma_f32_16x16x32_bf16 v[112:115], v[172:175], v[132:135], v[112:115]
  v_mul_u32_u24 v123, 12, v1
  v_add_u32 v124, 3072, v123
  s_waitcnt lgkmcnt(3)
  v_mfma_f32_32x32x16_bf16 v[16:31], v[128:131], v[144:147], v[16:31]
  ds_read_b128 v[132:135], v177
  ds_read_b64_tr_b16 v[160:161], v184 offset:6144
  v_add_u32 v176, 0xb000, v176
  s_lshl_b32 s69, s37, 8
  v_mfma_f32_32x32x16_bf16 v[32:47], v[136:139], v[144:147], v[32:47]
  s_add_u32 m0, s45, 0
  ds_read_b64_tr_b16 v[162:163], v184 offset:6656
  ds_read_b128 v[140:143], v181
  buffer_load_dwordx4 v186, s[4:7], s43 offen offset:0 lds
  v_mfma_f32_32x32x16_bf16 v[48:63], v[128:131], v[148:151], v[48:63]
  ds_read_b64_tr_b16 v[164:165], v184 offset:8192
  ds_read_b64_tr_b16 v[166:167], v184 offset:8704
  v_add_u32 v180, 0xb000, v180
  s_add_u32 s69, s69, 160768
  v_mfma_f32_32x32x16_bf16 v[64:79], v[136:139], v[148:151], v[64:79]
  ds_read_b64_tr_b16 v[168:169], v184 offset:10240
  ds_read_b64_tr_b16 v[170:171], v184 offset:10752
  buffer_load_dwordx4 v187, s[4:7], s43 offen offset:1024 lds
  s_cmp_eq_u32 s47, 2
  s_cselect_b32 s49, -7, 1
  s_waitcnt lgkmcnt(8)
  v_mfma_f32_32x32x16_bf16 v[80:95], v[152:155], v[128:131], v[80:95]
  ds_read_b128 v[172:175], v185 offset:32
  v_add_u32 v177, 0xb000, v177
  v_add_u32 v181, 0xb000, v181
  v_lshl_add_u32 v122, v1, 2, s69
  v_mfma_f32_32x32x16_bf16 v[96:111], v[152:155], v[136:139], v[96:111]
  buffer_load_dwordx4 v188, s[4:7], s43 offen offset:2048 lds
  s_lshl_b32 s87, s49, 7
  s_mul_i32 s66, s67, 576
  s_add_u32 s66, s66, 161280
  v_mfma_f32_16x16x32_bf16 v[112:115], v[156:159], v[128:131], v[112:115]
  buffer_load_dwordx4 v189, s[4:7], s43 offen offset:3072 lds
  s_add_u32 s43, s43, s87
  s_waitcnt lgkmcnt(3)
  v_mfma_f32_32x32x16_bf16 v[16:31], v[132:135], v[160:163], v[16:31]
  ds_read_b128 v[128:131], v178
  ds_read_b64_tr_b16 v[144:145], v184 offset:12288
  v_lshlrev_b32 v13, 4, v10
  v_lshl_add_u32 v13, v11, 3, v13
  v_mfma_f32_32x32x16_bf16 v[32:47], v[140:143], v[160:163], v[32:47]
  s_add_u32 m0, s46, 16384
  ds_read_b64_tr_b16 v[146:147], v184 offset:12800
  ds_read_b128 v[136:139], v182
  buffer_load_dwordx4 v190, s[88:91], s44 offen offset:0 lds
  v_mfma_f32_32x32x16_bf16 v[48:63], v[132:135], v[164:167], v[48:63]
  ds_read_b64_tr_b16 v[148:149], v184 offset:14336
  ds_read_b64_tr_b16 v[150:151], v184 offset:14848
  v_add_u32 v125, s66, v13
  v_bfe_u32 v13, v1, 2, 1
  v_mfma_f32_32x32x16_bf16 v[64:79], v[140:143], v[164:167], v[64:79]
  ds_read_b64_tr_b16 v[152:153], v184 offset:16384
  ds_read_b64_tr_b16 v[154:155], v184 offset:16896
  buffer_load_dwordx4 v191, s[88:91], s44 offen offset:1024 lds
  s_mul_i32 s49, s49, 196608
  s_waitcnt lgkmcnt(8)
  v_mfma_f32_32x32x16_bf16 v[80:95], v[168:171], v[132:135], v[80:95]
  ds_read_b128 v[156:159], v185 offset:64
  v_add_u32 v178, 0xb000, v178
  v_add_u32 v182, 0xb000, v182
  v_lshlrev_b32 v13, 4, v13
  v_mfma_f32_32x32x16_bf16 v[96:111], v[168:171], v[140:143], v[96:111]
  buffer_load_dwordx4 v192, s[88:91], s44 offen offset:2048 lds
  v_lshl_add_u32 v13, v15, 3, v13
  v_and_b32 v14, 3, v1
  v_lshl_add_u32 v13, v14, 1, v13
  v_mfma_f32_16x16x32_bf16 v[112:115], v[172:175], v[132:135], v[112:115]
  buffer_load_dwordx4 v193, s[88:91], s44 offen offset:3072 lds
  s_add_u32 s66, s66, 512
  s_waitcnt lgkmcnt(3)
  v_mfma_f32_32x32x16_bf16 v[16:31], v[128:131], v[144:147], v[16:31]
  ds_read_b128 v[132:135], v179
  ds_read_b64_tr_b16 v[160:161], v184 offset:18432
  v_add_u32 v126, s66, v13
  s_mul_i32 s66, s38, 1152
  v_mfma_f32_32x32x16_bf16 v[32:47], v[136:139], v[144:147], v[32:47]
  s_add_u32 m0, s46, 20480
  ds_read_b64_tr_b16 v[162:163], v184 offset:18944
  ds_read_b128 v[140:143], v183
  buffer_load_dwordx4 v194, s[88:91], s44 offen offset:0 lds
  v_mfma_f32_32x32x16_bf16 v[48:63], v[128:131], v[148:151], v[48:63]
  ds_read_b64_tr_b16 v[164:165], v184 offset:20480
  ds_read_b64_tr_b16 v[166:167], v184 offset:20992
  s_add_u32 s66, s66, 161280
  v_lshlrev_b32 v14, 4, v11
  v_mfma_f32_32x32x16_bf16 v[64:79], v[136:139], v[148:151], v[64:79]
  ds_read_b64_tr_b16 v[168:169], v184 offset:22528
  ds_read_b64_tr_b16 v[170:171], v184 offset:23040
  buffer_load_dwordx4 v195, s[88:91], s44 offen offset:1024 lds
  s_add_u32 s44, s44, s49
  s_waitcnt lgkmcnt(8)
  v_mfma_f32_32x32x16_bf16 v[80:95], v[152:155], v[128:131], v[80:95]
  ds_read_b128 v[172:175], v185 offset:96
  v_add_u32 v179, 0xb000, v179
  v_add_u32 v183, 0xb000, v183
  v_add_u32 v14, 512, v14
  v_mfma_f32_32x32x16_bf16 v[96:111], v[152:155], v[136:139], v[96:111]
  v_add_u32 v184, 0xb000, v184
  v_cndmask_b32 v13, v9, v14, s[62:63]
  v_add_u32 v127, s66, v13
  v_and_b32 v203, 3, v1
  v_mfma_f32_16x16x32_bf16 v[112:115], v[156:159], v[128:131], v[112:115]
  v_add_u32 v185, 128, v185
  v_lshlrev_b32 v203, 7, v203
  s_waitcnt lgkmcnt(0)
  v_mfma_f32_32x32x16_bf16 v[16:31], v[132:135], v[160:163], v[16:31]
  s_lshl2_add_u32 s66, s41, s36
  s_lshl_b32 s66, s66, 9
  s_add_u32 s94, s66, 65536
  s_add_u32 s95, s66, 131072
  v_mfma_f32_32x32x16_bf16 v[32:47], v[140:143], v[160:163], v[32:47]
  s_waitcnt vmcnt(10)
  s_barrier
  ds_read_b128 v[128:131], v176
  ds_read_b64_tr_b16 v[144:145], v184 offset:0
  s_mul_i32 s96, s41, 294912
  v_mfma_f32_32x32x16_bf16 v[48:63], v[132:135], v[164:167], v[48:63]
  ds_read_b64_tr_b16 v[146:147], v184 offset:512
  ds_read_b128 v[136:139], v180
  s_add_u32 s96, s96, 2211840
  s_lshl_b32 s66, s36, 13
  v_mfma_f32_32x32x16_bf16 v[64:79], v[140:143], v[164:167], v[64:79]
  ds_read_b64_tr_b16 v[148:149], v184 offset:2048
  ds_read_b64_tr_b16 v[150:151], v184 offset:2560
  s_add_u32 s96, s96, s66
  s_lshl_b32 s66, s42, 7
  v_mfma_f32_32x32x16_bf16 v[80:95], v[168:171], v[132:135], v[80:95]
  ds_read_b64_tr_b16 v[152:153], v184 offset:4096
  ds_read_b64_tr_b16 v[154:155], v184 offset:4608
  s_lshl_b32 s98, s41, 16
  s_add_u32 s98, s98, s66
  v_mfma_f32_32x32x16_bf16 v[96:111], v[168:171], v[140:143], v[96:111]
  ds_read_b128 v[156:159], v185 offset:0
  s_add_u32 s98, s98, s52
  s_add_u32 s99, s98, 8192
  s_lshl_b32 s66, s36, 15
  v_mfma_f32_16x16x32_bf16 v[112:115], v[172:175], v[132:135], v[112:115]
  s_lshl_b32 s68, s41, 8
  s_add_u32 s66, s66, s68
  s_waitcnt lgkmcnt(3)
  v_mfma_f32_32x32x16_bf16 v[16:31], v[128:131], v[144:147], v[16:31]
  ds_read_b128 v[132:135], v177
  ds_read_b64_tr_b16 v[160:161], v184 offset:6144
  v_add_u32 v176, 0xfffe3000, v176
  s_add_u32 s97, s66, 262144
  v_mfma_f32_32x32x16_bf16 v[32:47], v[136:139], v[144:147], v[32:47]
  s_add_u32 m0, s45, 73728
  ds_read_b64_tr_b16 v[162:163], v184 offset:6656
  ds_read_b128 v[140:143], v181
  buffer_load_dwordx4 v186, s[4:7], s43 offen offset:0 lds
  v_mfma_f32_32x32x16_bf16 v[48:63], v[128:131], v[148:151], v[48:63]
  ds_read_b64_tr_b16 v[164:165], v184 offset:8192
  ds_read_b64_tr_b16 v[166:167], v184 offset:8704
  v_add_u32 v180, 0xfffe3000, v180
  s_lshl_b32 s66, s36, 8
  v_mfma_f32_32x32x16_bf16 v[64:79], v[136:139], v[148:151], v[64:79]
  ds_read_b64_tr_b16 v[168:169], v184 offset:10240
  ds_read_b64_tr_b16 v[170:171], v184 offset:10752
  buffer_load_dwordx4 v187, s[4:7], s43 offen offset:1024 lds
  s_cmp_eq_u32 s47, 1
  s_cselect_b32 s49, -7, 1
  s_waitcnt lgkmcnt(8)
  v_mfma_f32_32x32x16_bf16 v[80:95], v[152:155], v[128:131], v[80:95]
  ds_read_b128 v[172:175], v185 offset:32
  v_add_u32 v177, 0xfffe3000, v177
  v_add_u32 v181, 0xfffe3000, v181
  s_add_u32 s66, s66, 114688
  v_mfma_f32_32x32x16_bf16 v[96:111], v[152:155], v[136:139], v[96:111]
  buffer_load_dwordx4 v188, s[4:7], s43 offen offset:2048 lds
  s_lshl_b32 s87, s49, 7
  v_lshlrev_b32 v206, 2, v1
  v_add_u32 v207, s66, v206
  v_mfma_f32_16x16x32_bf16 v[112:115], v[156:159], v[128:131], v[112:115]
  buffer_load_dwordx4 v189, s[4:7], s43 offen offset:3072 lds
  s_add_u32 s43, s43, s87
  s_waitcnt lgkmcnt(3)
  v_mfma_f32_32x32x16_bf16 v[16:31], v[132:135], v[160:163], v[16:31]
  ds_read_b128 v[128:131], v178
  ds_read_b64_tr_b16 v[144:145], v184 offset:12288
  v_lshl_add_u32 v208, v11, 4, s66
  s_lshl_b32 s66, s37, 13
  v_mfma_f32_32x32x16_bf16 v[32:47], v[140:143], v[160:163], v[32:47]
  s_add_u32 m0, s46, 90112
  ds_read_b64_tr_b16 v[146:147], v184 offset:12800
  ds_read_b128 v[136:139], v182
  buffer_load_dwordx4 v190, s[88:91], s44 offen offset:0 lds
  v_mfma_f32_32x32x16_bf16 v[48:63], v[132:135], v[164:167], v[48:63]
  ds_read_b64_tr_b16 v[148:149], v184 offset:14336
  ds_read_b64_tr_b16 v[150:151], v184 offset:14848
  s_lshl_b32 s67, s38, 11
  s_add_u32 s66, s66, s67
  v_mfma_f32_32x32x16_bf16 v[64:79], v[140:143], v[164:167], v[64:79]
  ds_read_b64_tr_b16 v[152:153], v184 offset:16384
  ds_read_b64_tr_b16 v[154:155], v184 offset:16896
  buffer_load_dwordx4 v191, s[88:91], s44 offen offset:1024 lds
  s_mul_i32 s49, s49, 196608
  s_waitcnt lgkmcnt(8)
  v_mfma_f32_32x32x16_bf16 v[80:95], v[168:171], v[132:135], v[80:95]
  ds_read_b128 v[156:159], v185 offset:64
  v_add_u32 v178, 0xfffe3000, v178
  v_add_u32 v182, 0xfffe3000, v182
  v_add_u32 v210, s66, v2
  v_mfma_f32_32x32x16_bf16 v[96:111], v[168:171], v[140:143], v[96:111]
  buffer_load_dwordx4 v192, s[88:91], s44 offen offset:2048 lds
  v_and_b32 v9, 1, v4
  v_lshl_add_u32 v9, v9, 2, v5
  v_lshlrev_b32 v13, 3, v6
  v_mfma_f32_16x16x32_bf16 v[112:115], v[172:175], v[132:135], v[112:115]
  buffer_load_dwordx4 v193, s[88:91], s44 offen offset:3072 lds
  v_lshl_add_u32 v211, v9, 10, v13
  s_waitcnt lgkmcnt(3)
  v_mfma_f32_32x32x16_bf16 v[16:31], v[128:131], v[144:147], v[16:31]
  ds_read_b128 v[132:135], v179
  ds_read_b64_tr_b16 v[160:161], v184 offset:18432
  v_mov_b32 v4, 0x3f803f80
  v_mov_b32 v5, 0x3f803f80
  v_mfma_f32_32x32x16_bf16 v[32:47], v[136:139], v[144:147], v[32:47]
  s_add_u32 m0, s46, 94208
  ds_read_b64_tr_b16 v[162:163], v184 offset:18944
  ds_read_b128 v[140:143], v183
  buffer_load_dwordx4 v194, s[88:91], s44 offen offset:0 lds
  v_mfma_f32_32x32x16_bf16 v[48:63], v[128:131], v[148:151], v[48:63]
  ds_read_b64_tr_b16 v[164:165], v184 offset:20480
  ds_read_b64_tr_b16 v[166:167], v184 offset:20992
  v_mov_b32 v6, 0x3f803f80
  v_mov_b32 v7, 0x3f803f80
  v_mfma_f32_32x32x16_bf16 v[64:79], v[136:139], v[148:151], v[64:79]
  ds_read_b64_tr_b16 v[168:169], v184 offset:22528
  ds_read_b64_tr_b16 v[170:171], v184 offset:23040
  buffer_load_dwordx4 v195, s[88:91], s44 offen offset:1024 lds
  s_add_u32 s44, s44, s49
  s_waitcnt lgkmcnt(8)
  v_mfma_f32_32x32x16_bf16 v[80:95], v[152:155], v[128:131], v[80:95]
  ds_read_b128 v[172:175], v185 offset:96
  v_add_u32 v179, 0xfffe3000, v179
  v_add_u32 v183, 0xfffe3000, v183
  v_mfma_f32_32x32x16_bf16 v[96:111], v[152:155], v[136:139], v[96:111]
  v_add_u32 v184, 0xfffe3000, v184
  v_mfma_f32_16x16x32_bf16 v[112:115], v[156:159], v[128:131], v[112:115]
  v_add_u32 v185, 128, v185
  s_waitcnt lgkmcnt(0)
  v_mfma_f32_32x32x16_bf16 v[16:31], v[132:135], v[160:163], v[16:31]
  v_mfma_f32_32x32x16_bf16 v[32:47], v[140:143], v[160:163], v[32:47]
  s_waitcnt vmcnt(10)
  s_barrier
  ds_read_b128 v[128:131], v176
  ds_read_b64_tr_b16 v[144:145], v184 offset:0
  v_mfma_f32_32x32x16_bf16 v[48:63], v[132:135], v[164:167], v[48:63]
  ds_read_b64_tr_b16 v[146:147], v184 offset:512
  ds_read_b128 v[136:139], v180
  v_mfma_f32_32x32x16_bf16 v[64:79], v[140:143], v[164:167], v[64:79]
  ds_read_b64_tr_b16 v[148:149], v184 offset:2048
  ds_read_b64_tr_b16 v[150:151], v184 offset:2560
  v_mfma_f32_32x32x16_bf16 v[80:95], v[168:171], v[132:135], v[80:95]
  ds_read_b64_tr_b16 v[152:153], v184 offset:4096
  ds_read_b64_tr_b16 v[154:155], v184 offset:4608
  v_mfma_f32_32x32x16_bf16 v[96:111], v[168:171], v[140:143], v[96:111]
  ds_read_b128 v[156:159], v185 offset:0
  v_mfma_f32_16x16x32_bf16 v[112:115], v[172:175], v[132:135], v[112:115]
  s_waitcnt lgkmcnt(3)
  v_mfma_f32_32x32x16_bf16 v[16:31], v[128:131], v[144:147], v[16:31]
  ds_read_b128 v[132:135], v177
  ds_read_b64_tr_b16 v[160:161], v184 offset:6144
  v_add_u32 v176, 0x12000, v176
  v_mfma_f32_32x32x16_bf16 v[32:47], v[136:139], v[144:147], v[32:47]
  s_add_u32 m0, s45, 118784
  ds_read_b64_tr_b16 v[162:163], v184 offset:6656
  ds_read_b128 v[140:143], v181
  buffer_load_dwordx4 v186, s[4:7], s43 offen offset:0 lds
  v_mfma_f32_32x32x16_bf16 v[48:63], v[128:131], v[148:151], v[48:63]
  ds_read_b64_tr_b16 v[164:165], v184 offset:8192
  ds_read_b64_tr_b16 v[166:167], v184 offset:8704
  v_add_u32 v180, 0x12000, v180
  v_mfma_f32_32x32x16_bf16 v[64:79], v[136:139], v[148:151], v[64:79]
  ds_read_b64_tr_b16 v[168:169], v184 offset:10240
  ds_read_b64_tr_b16 v[170:171], v184 offset:10752
  buffer_load_dwordx4 v187, s[4:7], s43 offen offset:1024 lds
  s_cmp_eq_u32 s47, 0
  s_cselect_b32 s49, -7, 1
  s_waitcnt lgkmcnt(8)
  v_mfma_f32_32x32x16_bf16 v[80:95], v[152:155], v[128:131], v[80:95]
  ds_read_b128 v[172:175], v185 offset:32
  v_add_u32 v177, 0x12000, v177
  v_add_u32 v181, 0x12000, v181
  v_mfma_f32_32x32x16_bf16 v[96:111], v[152:155], v[136:139], v[96:111]
  buffer_load_dwordx4 v188, s[4:7], s43 offen offset:2048 lds
  s_lshl_b32 s87, s49, 7
  v_mfma_f32_16x16x32_bf16 v[112:115], v[156:159], v[128:131], v[112:115]
  buffer_load_dwordx4 v189, s[4:7], s43 offen offset:3072 lds
  s_add_u32 s43, s43, s87
  s_waitcnt lgkmcnt(3)
  v_mfma_f32_32x32x16_bf16 v[16:31], v[132:135], v[160:163], v[16:31]
  ds_read_b128 v[128:131], v178
  ds_read_b64_tr_b16 v[144:145], v184 offset:12288
  v_mfma_f32_32x32x16_bf16 v[32:47], v[140:143], v[160:163], v[32:47]
  s_add_u32 m0, s46, 135168
  ds_read_b64_tr_b16 v[146:147], v184 offset:12800
  ds_read_b128 v[136:139], v182
  buffer_load_dwordx4 v190, s[88:91], s44 offen offset:0 lds
  v_mfma_f32_32x32x16_bf16 v[48:63], v[132:135], v[164:167], v[48:63]
  ds_read_b64_tr_b16 v[148:149], v184 offset:14336
  ds_read_b64_tr_b16 v[150:151], v184 offset:14848
  v_mfma_f32_32x32x16_bf16 v[64:79], v[140:143], v[164:167], v[64:79]
  ds_read_b64_tr_b16 v[152:153], v184 offset:16384
  ds_read_b64_tr_b16 v[154:155], v184 offset:16896
  buffer_load_dwordx4 v191, s[88:91], s44 offen offset:1024 lds
  s_mul_i32 s49, s49, 196608
  s_waitcnt lgkmcnt(8)
  v_mfma_f32_32x32x16_bf16 v[80:95], v[168:171], v[132:135], v[80:95]
  ds_read_b128 v[156:159], v185 offset:64
  v_add_u32 v178, 0x12000, v178
  v_add_u32 v182, 0x12000, v182
  v_mfma_f32_32x32x16_bf16 v[96:111], v[168:171], v[140:143], v[96:111]
  buffer_load_dwordx4 v192, s[88:91], s44 offen offset:2048 lds
  v_mfma_f32_16x16x32_bf16 v[112:115], v[172:175], v[132:135], v[112:115]
  buffer_load_dwordx4 v193, s[88:91], s44 offen offset:3072 lds
  s_waitcnt lgkmcnt(3)
  v_mfma_f32_32x32x16_bf16 v[16:31], v[128:131], v[144:147], v[16:31]
  ds_read_b128 v[132:135], v179
  ds_read_b64_tr_b16 v[160:161], v184 offset:18432
  v_mfma_f32_32x32x16_bf16 v[32:47], v[136:139], v[144:147], v[32:47]
  s_add_u32 m0, s46, 139264
  ds_read_b64_tr_b16 v[162:163], v184 offset:18944
  ds_read_b128 v[140:143], v183
  buffer_load_dwordx4 v194, s[88:91], s44 offen offset:0 lds
  v_mfma_f32_32x32x16_bf16 v[48:63], v[128:131], v[148:151], v[48:63]
  ds_read_b64_tr_b16 v[164:165], v184 offset:20480
  ds_read_b64_tr_b16 v[166:167], v184 offset:20992
  v_mfma_f32_32x32x16_bf16 v[64:79], v[136:139], v[148:151], v[64:79]
  ds_read_b64_tr_b16 v[168:169], v184 offset:22528
  ds_read_b64_tr_b16 v[170:171], v184 offset:23040
  buffer_load_dwordx4 v195, s[88:91], s44 offen offset:1024 lds
  s_add_u32 s44, s44, s49
  s_waitcnt lgkmcnt(8)
  v_mfma_f32_32x32x16_bf16 v[80:95], v[152:155], v[128:131], v[80:95]
  ds_read_b128 v[172:175], v185 offset:96
  v_add_u32 v179, 0x12000, v179
  v_add_u32 v183, 0x12000, v183
  v_mfma_f32_32x32x16_bf16 v[96:111], v[152:155], v[136:139], v[96:111]
  v_add_u32 v184, 0x12000, v184
  v_mfma_f32_16x16x32_bf16 v[112:115], v[156:159], v[128:131], v[112:115]
  v_add_u32 v185, 128, v185
  s_waitcnt lgkmcnt(0)
  v_mfma_f32_32x32x16_bf16 v[16:31], v[132:135], v[160:163], v[16:31]
  v_mfma_f32_32x32x16_bf16 v[32:47], v[140:143], v[160:163], v[32:47]
  s_waitcnt vmcnt(10)
  s_barrier
  ds_read_b128 v[128:131], v176
  ds_read_b64_tr_b16 v[144:145], v184 offset:0
  v_mfma_f32_32x32x16_bf16 v[48:63], v[132:135], v[164:167], v[48:63]
  ds_read_b64_tr_b16 v[146:147], v184 offset:512
  ds_read_b128 v[136:139], v180
  v_mfma_f32_32x32x16_bf16 v[64:79], v[140:143], v[164:167], v[64:79]
  ds_read_b64_tr_b16 v[148:149], v184 offset:2048
  ds_read_b64_tr_b16 v[150:151], v184 offset:2560
  v_mfma_f32_32x32x16_bf16 v[80:95], v[168:171], v[132:135], v[80:95]
  ds_read_b64_tr_b16 v[152:153], v184 offset:4096
  ds_read_b64_tr_b16 v[154:155], v184 offset:4608
  v_mfma_f32_32x32x16_bf16 v[96:111], v[168:171], v[140:143], v[96:111]
  ds_read_b128 v[156:159], v185 offset:0
  v_mfma_f32_16x16x32_bf16 v[112:115], v[172:175], v[132:135], v[112:115]
  s_waitcnt lgkmcnt(3)
  v_mfma_f32_32x32x16_bf16 v[16:31], v[128:131], v[144:147], v[16:31]
  ds_read_b128 v[132:135], v177
  ds_read_b64_tr_b16 v[160:161], v184 offset:6144
  v_add_u32 v176, 0xb000, v176
  buffer_load_dword v205, v3, s[20:23], 0 offen sc1
  v_mfma_f32_32x32x16_bf16 v[32:47], v[136:139], v[144:147], v[32:47]
  ds_read_b64_tr_b16 v[162:163], v184 offset:6656
  ds_read_b128 v[140:143], v181
  v_mfma_f32_32x32x16_bf16 v[48:63], v[128:131], v[148:151], v[48:63]
  ds_read_b64_tr_b16 v[164:165], v184 offset:8192
  ds_read_b64_tr_b16 v[166:167], v184 offset:8704
  v_add_u32 v180, 0xb000, v180
  v_mfma_f32_32x32x16_bf16 v[64:79], v[136:139], v[148:151], v[64:79]
  s_add_u32 m0, s52, 0
  ds_read_b64_tr_b16 v[168:169], v184 offset:10240
  ds_read_b64_tr_b16 v[170:171], v184 offset:10752
  s_bfe_u32 s69, s48, 0x80000
  s_lshl_b32 s69, s69, 14
  s_add_u32 s51, s69, s100
  buffer_load_dwordx4 v197, s[24:27], s51 offen lds
  s_waitcnt lgkmcnt(8)
  v_mfma_f32_32x32x16_bf16 v[80:95], v[152:155], v[128:131], v[80:95]
  ds_read_b128 v[172:175], v185 offset:32
  v_add_u32 v177, 0xb000, v177
  v_add_u32 v181, 0xb000, v181
  v_mfma_f32_32x32x16_bf16 v[96:111], v[152:155], v[136:139], v[96:111]
  buffer_load_dwordx4 v198, s[24:27], s51 offen offset:1024 lds
  s_add_u32 s51, s51, 16384
  v_mfma_f32_16x16x32_bf16 v[112:115], v[156:159], v[128:131], v[112:115]
  s_add_u32 m0, s52, 2048
  s_nop 0
  buffer_load_dwordx4 v197, s[24:27], s51 offen lds
  s_waitcnt lgkmcnt(3)
  v_mfma_f32_32x32x16_bf16 v[16:31], v[132:135], v[160:163], v[16:31]
  ds_read_b128 v[128:131], v178
  ds_read_b64_tr_b16 v[144:145], v184 offset:12288
  v_mfma_f32_32x32x16_bf16 v[32:47], v[140:143], v[160:163], v[32:47]
  ds_read_b64_tr_b16 v[146:147], v184 offset:12800
  ds_read_b128 v[136:139], v182
  buffer_load_dwordx4 v198, s[24:27], s51 offen offset:1024 lds
  s_add_u32 s51, s51, 16384
  v_mfma_f32_32x32x16_bf16 v[48:63], v[132:135], v[164:167], v[48:63]
  ds_read_b64_tr_b16 v[148:149], v184 offset:14336
  ds_read_b64_tr_b16 v[150:151], v184 offset:14848
  v_mfma_f32_32x32x16_bf16 v[64:79], v[140:143], v[164:167], v[64:79]
  s_add_u32 m0, s52, 4096
  ds_read_b64_tr_b16 v[152:153], v184 offset:16384
  ds_read_b64_tr_b16 v[154:155], v184 offset:16896
  buffer_load_dwordx4 v197, s[24:27], s51 offen lds
  s_waitcnt lgkmcnt(8)
  v_mfma_f32_32x32x16_bf16 v[80:95], v[168:171], v[132:135], v[80:95]
  ds_read_b128 v[156:159], v185 offset:64
  v_add_u32 v178, 0xb000, v178
  v_add_u32 v182, 0xb000, v182
  v_mfma_f32_32x32x16_bf16 v[96:111], v[168:171], v[140:143], v[96:111]
  buffer_load_dwordx4 v198, s[24:27], s51 offen offset:1024 lds
  s_add_u32 s51, s51, 16384
  v_mfma_f32_16x16x32_bf16 v[112:115], v[172:175], v[132:135], v[112:115]
  s_add_u32 m0, s52, 6144
  s_nop 0
  buffer_load_dwordx4 v197, s[24:27], s51 offen lds
  s_waitcnt lgkmcnt(3)
  v_mfma_f32_32x32x16_bf16 v[16:31], v[128:131], v[144:147], v[16:31]
  ds_read_b128 v[132:135], v179
  ds_read_b64_tr_b16 v[160:161], v184 offset:18432
  v_mfma_f32_32x32x16_bf16 v[32:47], v[136:139], v[144:147], v[32:47]
  ds_read_b64_tr_b16 v[162:163], v184 offset:18944
  ds_read_b128 v[140:143], v183
  v_mfma_f32_32x32x16_bf16 v[48:63], v[128:131], v[148:151], v[48:63]
  ds_read_b64_tr_b16 v[164:165], v184 offset:20480
  ds_read_b64_tr_b16 v[166:167], v184 offset:20992
  v_mfma_f32_32x32x16_bf16 v[64:79], v[136:139], v[148:151], v[64:79]
  ds_read_b64_tr_b16 v[168:169], v184 offset:22528
  ds_read_b64_tr_b16 v[170:171], v184 offset:23040
  buffer_load_dwordx4 v198, s[24:27], s51 offen offset:1024 lds
  s_add_u32 s51, s51, 16384
  s_waitcnt lgkmcnt(8)
  v_mfma_f32_32x32x16_bf16 v[80:95], v[152:155], v[128:131], v[80:95]
  ds_read_b128 v[172:175], v185 offset:96
  v_add_u32 v179, 0xb000, v179
  v_add_u32 v183, 0xb000, v183
  v_mfma_f32_32x32x16_bf16 v[96:111], v[152:155], v[136:139], v[96:111]
  s_add_u32 m0, s52, 8192
  s_bfe_u32 s69, s0, 0x80000
  s_lshl_b32 s69, s69, 14
  s_add_u32 s51, s69, s100
  buffer_load_dwordx4 v197, s[24:27], s51 offen lds
  v_add_u32 v184, 0xb000, v184
  v_mfma_f32_16x16x32_bf16 v[112:115], v[156:159], v[128:131], v[112:115]
  buffer_load_dwordx4 v198, s[24:27], s51 offen offset:1024 lds
  s_add_u32 s51, s51, 16384
  v_add_u32 v185, 128, v185
  s_waitcnt lgkmcnt(0)
  v_mfma_f32_32x32x16_bf16 v[16:31], v[132:135], v[160:163], v[16:31]
  v_mfma_f32_32x32x16_bf16 v[32:47], v[140:143], v[160:163], v[32:47]
  s_waitcnt vmcnt(11)
  s_barrier
  ds_read_b128 v[128:131], v176
  ds_read_b64_tr_b16 v[144:145], v184 offset:0
  v_mfma_f32_32x32x16_bf16 v[48:63], v[132:135], v[164:167], v[48:63]
  s_add_u32 m0, s52, 10240
  ds_read_b64_tr_b16 v[146:147], v184 offset:512
  ds_read_b128 v[136:139], v180
  buffer_load_dwordx4 v197, s[24:27], s51 offen lds
  v_mfma_f32_32x32x16_bf16 v[64:79], v[140:143], v[164:167], v[64:79]
  ds_read_b64_tr_b16 v[148:149], v184 offset:2048
  ds_read_b64_tr_b16 v[150:151], v184 offset:2560
  buffer_load_dwordx4 v198, s[24:27], s51 offen offset:1024 lds
  s_add_u32 s51, s51, 16384
  v_mfma_f32_32x32x16_bf16 v[80:95], v[168:171], v[132:135], v[80:95]
  s_add_u32 m0, s52, 12288
  ds_read_b64_tr_b16 v[152:153], v184 offset:4096
  ds_read_b64_tr_b16 v[154:155], v184 offset:4608
  buffer_load_dwordx4 v197, s[24:27], s51 offen lds
  v_mfma_f32_32x32x16_bf16 v[96:111], v[168:171], v[140:143], v[96:111]
  ds_read_b128 v[156:159], v185 offset:0
  buffer_load_dwordx4 v198, s[24:27], s51 offen offset:1024 lds
  s_add_u32 s51, s51, 16384
  v_mfma_f32_16x16x32_bf16 v[112:115], v[172:175], v[132:135], v[112:115]
  s_waitcnt lgkmcnt(3)
  v_mfma_f32_32x32x16_bf16 v[16:31], v[128:131], v[144:147], v[16:31]
  ds_read_b128 v[132:135], v177
  ds_read_b64_tr_b16 v[160:161], v184 offset:6144
  v_mfma_f32_32x32x16_bf16 v[32:47], v[136:139], v[144:147], v[32:47]
  ds_read_b64_tr_b16 v[162:163], v184 offset:6656
  ds_read_b128 v[140:143], v181
  v_mfma_f32_32x32x16_bf16 v[48:63], v[128:131], v[148:151], v[48:63]
  ds_read_b64_tr_b16 v[164:165], v184 offset:8192
  ds_read_b64_tr_b16 v[166:167], v184 offset:8704
  v_mfma_f32_32x32x16_bf16 v[64:79], v[136:139], v[148:151], v[64:79]
  s_add_u32 m0, s52, 14336
  ds_read_b64_tr_b16 v[168:169], v184 offset:10240
  ds_read_b64_tr_b16 v[170:171], v184 offset:10752
  s_bfe_u32 s69, s1, 0x80000
  s_lshl_b32 s69, s69, 14
  s_add_u32 s51, s69, s54
  buffer_load_dwordx4 v197, s[8:11], s51 offen lds
  s_waitcnt lgkmcnt(8)
  v_mfma_f32_32x32x16_bf16 v[80:95], v[152:155], v[128:131], v[80:95]
  ds_read_b128 v[172:175], v185 offset:32
  v_mfma_f32_32x32x16_bf16 v[96:111], v[152:155], v[136:139], v[96:111]
  buffer_load_dwordx4 v198, s[8:11], s51 offen offset:1024 lds
  s_add_u32 s51, s51, 16384
  v_mfma_f32_16x16x32_bf16 v[112:115], v[156:159], v[128:131], v[112:115]
  s_waitcnt lgkmcnt(3)
  v_mfma_f32_32x32x16_bf16 v[16:31], v[132:135], v[160:163], v[16:31]
  ds_read_b128 v[128:131], v178
  ds_read_b64_tr_b16 v[144:145], v184 offset:12288
  v_mfma_f32_32x32x16_bf16 v[32:47], v[140:143], v[160:163], v[32:47]
  s_add_u32 m0, s53, 0
  ds_read_b64_tr_b16 v[146:147], v184 offset:12800
  ds_read_b128 v[136:139], v182
  buffer_load_dwordx4 v197, s[8:11], s51 offen lds
  v_mfma_f32_32x32x16_bf16 v[48:63], v[132:135], v[164:167], v[48:63]
  ds_read_b64_tr_b16 v[148:149], v184 offset:14336
  ds_read_b64_tr_b16 v[150:151], v184 offset:14848
  v_mfma_f32_32x32x16_bf16 v[64:79], v[140:143], v[164:167], v[64:79]
  ds_read_b64_tr_b16 v[152:153], v184 offset:16384
  ds_read_b64_tr_b16 v[154:155], v184 offset:16896
  buffer_load_dwordx4 v198, s[8:11], s51 offen offset:1024 lds
  s_add_u32 s51, s51, 16384
  s_waitcnt lgkmcnt(8)
  v_mfma_f32_32x32x16_bf16 v[80:95], v[168:171], v[132:135], v[80:95]
  ds_read_b128 v[156:159], v185 offset:64
  v_mfma_f32_32x32x16_bf16 v[96:111], v[168:171], v[140:143], v[96:111]
  v_mfma_f32_16x16x32_bf16 v[112:115], v[172:175], v[132:135], v[112:115]
  s_add_u32 m0, s53, 2048
  s_bfe_u32 s69, s48, 0x80008
  s_lshl_b32 s69, s69, 14
  s_add_u32 s51, s69, s100
  buffer_load_dwordx4 v197, s[24:27], s51 offen lds
  s_waitcnt lgkmcnt(3)
  v_mfma_f32_32x32x16_bf16 v[16:31], v[128:131], v[144:147], v[16:31]
  ds_read_b128 v[132:135], v179
  ds_read_b64_tr_b16 v[160:161], v184 offset:18432
  v_mfma_f32_32x32x16_bf16 v[32:47], v[136:139], v[144:147], v[32:47]
  ds_read_b64_tr_b16 v[162:163], v184 offset:18944
  ds_read_b128 v[140:143], v183
  buffer_load_dwordx4 v198, s[24:27], s51 offen offset:1024 lds
  s_add_u32 s51, s51, 16384
  v_mfma_f32_32x32x16_bf16 v[48:63], v[128:131], v[148:151], v[48:63]
  ds_read_b64_tr_b16 v[164:165], v184 offset:20480
  ds_read_b64_tr_b16 v[166:167], v184 offset:20992
  v_mfma_f32_32x32x16_bf16 v[64:79], v[136:139], v[148:151], v[64:79]
  ds_read_b64_tr_b16 v[168:169], v184 offset:22528
  ds_read_b64_tr_b16 v[170:171], v184 offset:23040
  s_waitcnt lgkmcnt(8)
  v_mfma_f32_32x32x16_bf16 v[80:95], v[152:155], v[128:131], v[80:95]
  ds_read_b128 v[172:175], v185 offset:96
  v_mfma_f32_32x32x16_bf16 v[96:111], v[152:155], v[136:139], v[96:111]
  s_add_u32 m0, s53, 4096
  s_nop 0
  buffer_load_dwordx4 v197, s[24:27], s51 offen lds
  v_mfma_f32_16x16x32_bf16 v[112:115], v[156:159], v[128:131], v[112:115]
  buffer_load_dwordx4 v198, s[24:27], s51 offen offset:1024 lds
  s_add_u32 s51, s51, 16384
  s_waitcnt lgkmcnt(0)
  v_mfma_f32_32x32x16_bf16 v[16:31], v[132:135], v[160:163], v[16:31]
  v_mfma_f32_32x32x16_bf16 v[32:47], v[140:143], v[160:163], v[32:47]
  s_barrier
  v_mfma_f32_32x32x16_bf16 v[48:63], v[132:135], v[164:167], v[48:63]
  s_add_u32 m0, s53, 6144
  s_nop 0
  buffer_load_dwordx4 v197, s[24:27], s51 offen lds
  v_mfma_f32_32x32x16_bf16 v[64:79], v[140:143], v[164:167], v[64:79]
  buffer_load_dwordx4 v198, s[24:27], s51 offen offset:1024 lds
  s_add_u32 s51, s51, 16384
  v_mfma_f32_32x32x16_bf16 v[80:95], v[168:171], v[132:135], v[80:95]
  s_add_u32 m0, s53, 8192
  s_nop 0
  buffer_load_dwordx4 v197, s[24:27], s51 offen lds
  v_mfma_f32_32x32x16_bf16 v[96:111], v[168:171], v[140:143], v[96:111]
  buffer_load_dwordx4 v198, s[24:27], s51 offen offset:1024 lds
  s_add_u32 s51, s51, 16384
  v_mfma_f32_16x16x32_bf16 v[112:115], v[172:175], v[132:135], v[112:115]
  v_pk_mul_f32 v[216:217], v[16:17], s[64:65]
  v_pk_mul_f32 v[218:219], v[18:19], s[64:65]
  v_pk_mul_f32 v[220:221], v[20:21], s[64:65]
  v_pk_mul_f32 v[222:223], v[22:23], s[64:65]
  v_pk_add_f32 v[224:225], v[16:17], s[60:61]
  v_pk_add_f32 v[226:227], v[18:19], s[60:61]
  v_pk_add_f32 v[228:229], v[20:21], s[60:61]
  v_pk_add_f32 v[230:231], v[22:23], s[60:61]
  v_exp_f32 v216, v216 clamp
  v_exp_f32 v217, v217 clamp
  v_exp_f32 v218, v218 clamp
  v_exp_f32 v219, v219 clamp
  v_exp_f32 v220, v220 clamp
  v_exp_f32 v221, v221 clamp
  v_exp_f32 v222, v222 clamp
  v_exp_f32 v223, v223 clamp
  v_max_f32 v224, s60, v224
  v_max_f32 v225, s60, v225
  v_max_f32 v226, s60, v226
  v_max_f32 v227, s60, v227
  v_max_f32 v228, s60, v228
  v_max_f32 v229, s60, v229
  v_max_f32 v230, s60, v230
  v_max_f32 v231, s60, v231
  v_cvt_pk_bf16_f32 v144, v48, v49
  v_cvt_pk_bf16_f32 v145, v50, v51
  v_cvt_pk_bf16_f32 v146, v52, v53
  v_cvt_pk_bf16_f32 v147, v54, v55
  v_pk_add_f32 v[216:217], v[216:217], v[224:225]
  v_pk_add_f32 v[218:219], v[218:219], v[226:227]
  v_pk_add_f32 v[220:221], v[220:221], v[228:229]
  v_pk_add_f32 v[222:223], v[222:223], v[230:231]
  v_cvt_pk_bf16_f32 v128, v216, v217
  v_cvt_pk_bf16_f32 v129, v218, v219
  v_cvt_pk_bf16_f32 v130, v220, v221
  v_cvt_pk_bf16_f32 v131, v222, v223
  v_pk_mul_f32 v[232:233], v[24:25], s[64:65]
  v_pk_mul_f32 v[234:235], v[26:27], s[64:65]
  v_pk_mul_f32 v[236:237], v[28:29], s[64:65]
  v_pk_mul_f32 v[238:239], v[30:31], s[64:65]
  v_pk_add_f32 v[240:241], v[24:25], s[60:61]
  v_pk_add_f32 v[242:243], v[26:27], s[60:61]
  v_pk_add_f32 v[244:245], v[28:29], s[60:61]
  v_pk_add_f32 v[246:247], v[30:31], s[60:61]
  v_mfma_f32_32x32x16_bf16 v[168:183], v[128:131], v[4:7], 0
  v_exp_f32 v232, v232 clamp
  v_exp_f32 v233, v233 clamp
  v_exp_f32 v234, v234 clamp
  v_exp_f32 v235, v235 clamp
  v_exp_f32 v236, v236 clamp
  v_exp_f32 v237, v237 clamp
  v_exp_f32 v238, v238 clamp
  v_exp_f32 v239, v239 clamp
  v_max_f32 v240, s60, v240
  v_max_f32 v241, s60, v241
  v_max_f32 v242, s60, v242
  v_max_f32 v243, s60, v243
  v_max_f32 v244, s60, v244
  v_max_f32 v245, s60, v245
  v_max_f32 v246, s60, v246
  v_max_f32 v247, s60, v247
  v_cvt_pk_bf16_f32 v148, v56, v57
  v_cvt_pk_bf16_f32 v149, v58, v59
  v_cvt_pk_bf16_f32 v150, v60, v61
  v_cvt_pk_bf16_f32 v151, v62, v63
  v_pk_add_f32 v[232:233], v[232:233], v[240:241]
  v_pk_add_f32 v[234:235], v[234:235], v[242:243]
  v_pk_add_f32 v[236:237], v[236:237], v[244:245]
  v_pk_add_f32 v[238:239], v[238:239], v[246:247]
  v_cvt_pk_bf16_f32 v132, v232, v233
  v_cvt_pk_bf16_f32 v133, v234, v235
  v_cvt_pk_bf16_f32 v134, v236, v237
  v_cvt_pk_bf16_f32 v135, v238, v239
  s_waitcnt vmcnt(26)
  v_readfirstlane_b32 s50, v205
  s_cmp_lg_u32 s50, 0
  s_cbranch_scc1 L_ok_9
L_retry_10:
  s_sub_u32 s75, s75, 1
  s_cmp_lt_i32 s75, 0
  s_cbranch_scc1 L_ok_9
  buffer_load_dword v205, v3, s[20:23], 0 offen sc1
  s_waitcnt vmcnt(0)
  v_readfirstlane_b32 s50, v205
  s_cmp_lg_u32 s50, 0
  s_cbranch_scc0 L_retry_10
L_ok_9:
  s_and_b32 s55, s50, 0xbfff
  v_pk_mul_f32 v[216:217], v[32:33], s[64:65]
  v_pk_mul_f32 v[218:219], v[34:35], s[64:65]
  v_pk_mul_f32 v[220:221], v[36:37], s[64:65]
  v_pk_mul_f32 v[222:223], v[38:39], s[64:65]
  v_pk_add_f32 v[224:225], v[32:33], s[60:61]
  v_pk_add_f32 v[226:227], v[34:35], s[60:61]
  v_pk_add_f32 v[228:229], v[36:37], s[60:61]
  v_pk_add_f32 v[230:231], v[38:39], s[60:61]
  v_mfma_f32_32x32x16_bf16 v[16:31], v[128:131], v[144:147], 0
  v_mul_f32 v164, s56, v112
  v_exp_f32 v164, v164
  v_exp_f32 v216, v216 clamp
  v_exp_f32 v217, v217 clamp
  v_exp_f32 v218, v218 clamp
  v_exp_f32 v219, v219 clamp
  v_exp_f32 v220, v220 clamp
  v_exp_f32 v221, v221 clamp
  v_exp_f32 v222, v222 clamp
  v_exp_f32 v223, v223 clamp
  v_mfma_f32_32x32x16_bf16 v[168:183], v[132:135], v[4:7], v[168:183]
  v_add_f32 v164, 1.0, v164
  v_rcp_f32 v164, v164
  v_max_f32 v224, s60, v224
  v_max_f32 v225, s60, v225
  v_max_f32 v226, s60, v226
  v_max_f32 v227, s60, v227
  v_max_f32 v228, s60, v228
  v_max_f32 v229, s60, v229
  v_max_f32 v230, s60, v230
  v_max_f32 v231, s60, v231
  v_mfma_f32_32x32x16_bf16 v[16:31], v[132:135], v[148:151], v[16:31]
  v_cvt_pk_bf16_f32 v152, v64, v65
  v_cvt_pk_bf16_f32 v153, v66, v67
  v_cvt_pk_bf16_f32 v154, v68, v69
  v_cvt_pk_bf16_f32 v155, v70, v71
  v_pk_add_f32 v[216:217], v[216:217], v[224:225]
  v_pk_add_f32 v[218:219], v[218:219], v[226:227]
  v_pk_add_f32 v[220:221], v[220:221], v[228:229]
  v_pk_add_f32 v[222:223], v[222:223], v[230:231]
  v_cvt_pk_bf16_f32 v136, v216, v217
  v_cvt_pk_bf16_f32 v137, v218, v219
  v_cvt_pk_bf16_f32 v138, v220, v221
  v_cvt_pk_bf16_f32 v139, v222, v223
  v_pk_mul_f32 v[232:233], v[40:41], s[64:65]
  v_pk_mul_f32 v[234:235], v[42:43], s[64:65]
  v_pk_mul_f32 v[236:237], v[44:45], s[64:65]
  v_pk_mul_f32 v[238:239], v[46:47], s[64:65]
  v_pk_add_f32 v[240:241], v[40:41], s[60:61]
  v_pk_add_f32 v[242:243], v[42:43], s[60:61]
  v_pk_add_f32 v[244:245], v[44:45], s[60:61]
  v_pk_add_f32 v[246:247], v[46:47], s[60:61]
  v_mfma_f32_32x32x16_bf16 v[168:183], v[136:139], v[4:7], v[168:183]
  ds_write_b32 v118, v164
  v_exp_f32 v232, v232 clamp
  v_exp_f32 v233, v233 clamp
  v_exp_f32 v234, v234 clamp
  v_exp_f32 v235, v235 clamp
  v_exp_f32 v236, v236 clamp
  v_exp_f32 v237, v237 clamp
  v_exp_f32 v238, v238 clamp
  v_exp_f32 v239, v239 clamp
  v_mfma_f32_32x32x16_bf16 v[16:31], v[136:139], v[152:155], v[16:31]
  v_mov_b32 v213, s55
  v_max_f32 v240, s60, v240
  v_max_f32 v241, s60, v241
  v_max_f32 v242, s60, v242
  v_max_f32 v243, s60, v243
  v_max_f32 v244, s60, v244
  v_max_f32 v245, s60, v245
  v_max_f32 v246, s60, v246
  v_max_f32 v247, s60, v247
  v_cvt_pk_bf16_f32 v156, v72, v73
  v_cvt_pk_bf16_f32 v157, v74, v75
  v_cvt_pk_bf16_f32 v158, v76, v77
  v_cvt_pk_bf16_f32 v159, v78, v79
  v_pk_add_f32 v[232:233], v[232:233], v[240:241]
  v_pk_add_f32 v[234:235], v[234:235], v[242:243]
  v_pk_add_f32 v[236:237], v[236:237], v[244:245]
  v_pk_add_f32 v[238:239], v[238:239], v[246:247]
  v_cvt_pk_bf16_f32 v140, v232, v233
  v_cvt_pk_bf16_f32 v141, v234, v235
  v_cvt_pk_bf16_f32 v142, v236, v237
  v_cvt_pk_bf16_f32 v143, v238, v239
  s_nop 1
  v_mfma_f32_32x32x16_bf16 v[168:183], v[140:143], v[4:7], v[168:183]
  v_mfma_f32_32x32x16_bf16 v[16:31], v[140:143], v[156:159], v[16:31]
  s_nop 11
  v_cndmask_b32 v48, v16, v168, s[62:63]
  v_cndmask_b32 v49, v17, v169, s[62:63]
  v_cndmask_b32 v50, v18, v170, s[62:63]
  v_cndmask_b32 v51, v19, v171, s[62:63]
  ds_write_b128 v116, v[48:51] offset:0
  v_cndmask_b32 v52, v20, v172, s[62:63]
  v_cndmask_b32 v53, v21, v173, s[62:63]
  v_cndmask_b32 v54, v22, v174, s[62:63]
  v_cndmask_b32 v55, v23, v175, s[62:63]
  ds_write_b128 v116, v[52:55] offset:512
  v_cndmask_b32 v56, v176, v24, s[62:63]
  v_cndmask_b32 v57, v177, v25, s[62:63]
  v_cndmask_b32 v58, v178, v26, s[62:63]
  v_cndmask_b32 v59, v179, v27, s[62:63]
  ds_write_b128 v117, v[56:59] offset:0
  v_cndmask_b32 v60, v180, v28, s[62:63]
  v_cndmask_b32 v61, v181, v29, s[62:63]
  v_cndmask_b32 v62, v182, v30, s[62:63]
  v_cndmask_b32 v63, v183, v31, s[62:63]
  ds_write_b128 v117, v[60:63] offset:512
  s_waitcnt lgkmcnt(0)
  s_barrier
  ds_read_b128 v[64:67], v120
  ds_read_b128 v[68:71], v120 offset:4096
  ds_read_b32 v72, v121
  ds_read_b32 v73, v121 offset:128
  ds_read_b32 v165, v119
  ds_read_b32 v166, v122
  s_waitcnt lgkmcnt(4)
  v_pk_add_f32 v[64:65], v[64:65], v[68:69]
  v_pk_add_f32 v[66:67], v[66:67], v[70:71]
  s_waitcnt lgkmcnt(2)
  v_add_f32 v72, v72, v73
  v_cvt_pk_bf16_f32 v64, v64, v65
  v_cvt_pk_bf16_f32 v65, v66, v67
  v_cvt_pk_bf16_f32 v66, v72, v72
  v_and_or_b32 v66, v66, s62, v213
  buffer_store_dwordx3 v[64:66], v123, s[28:31], s92 offen sc1
  v_pk_mul_f32 v[216:217], v[80:81], s[64:65]
  v_pk_mul_f32 v[218:219], v[82:83], s[64:65]
  v_pk_mul_f32 v[220:221], v[84:85], s[64:65]
  v_pk_mul_f32 v[222:223], v[86:87], s[64:65]
  v_pk_add_f32 v[224:225], v[80:81], s[60:61]
  v_pk_add_f32 v[226:227], v[82:83], s[60:61]
  v_pk_add_f32 v[228:229], v[84:85], s[60:61]
  v_pk_add_f32 v[230:231], v[86:87], s[60:61]
  s_bfe_u32 s69, s48, 0x80010
  s_lshl_b32 s69, s69, 14
  s_add_u32 s51, s69, s100
  s_add_u32 m0, s53, 45056
  s_nop 0
  buffer_load_dwordx4 v197, s[24:27], s51 offen lds
  buffer_load_dwordx4 v198, s[24:27], s51 offen offset:1024 lds
  s_add_u32 s51, s51, 16384
  s_add_u32 m0, s53, 47104
  s_nop 0
  buffer_load_dwordx4 v197, s[24:27], s51 offen lds
  buffer_load_dwordx4 v198, s[24:27], s51 offen offset:1024 lds
  s_add_u32 s51, s51, 16384
  v_exp_f32 v216, v216 clamp
  v_exp_f32 v217, v217 clamp
  v_exp_f32 v218, v218 clamp
  v_exp_f32 v219, v219 clamp
  v_exp_f32 v220, v220 clamp
  v_exp_f32 v221, v221 clamp
  v_exp_f32 v222, v222 clamp
  v_exp_f32 v223, v223 clamp
  s_waitcnt vmcnt(29)
  ds_read_b64_tr_b16 a[0:1], v199 offset:0
  ds_read_b64_tr_b16 a[2:3], v199 offset:1024
  ds_read_b64_tr_b16 a[4:5], v200 offset:0
  ds_read_b64_tr_b16 a[6:7], v200 offset:1024
  s_waitcnt vmcnt(27)
  ds_read_b64_tr_b16 a[8:9], v199 offset:2048
  ds_read_b64_tr_b16 a[10:11], v199 offset:3072
  ds_read_b64_tr_b16 a[12:13], v200 offset:2048
  ds_read_b64_tr_b16 a[14:15], v200 offset:3072
  s_waitcnt vmcnt(25)
  ds_read_b64_tr_b16 a[16:17], v199 offset:4096
  ds_read_b64_tr_b16 a[18:19], v199 offset:5120
  ds_read_b64_tr_b16 a[20:21], v200 offset:4096
  ds_read_b64_tr_b16 a[22:23], v200 offset:5120
  v_max_f32 v224, s60, v224
  v_max_f32 v225, s60, v225
  v_max_f32 v226, s60, v226
  v_max_f32 v227, s60, v227
  v_max_f32 v228, s60, v228
  v_max_f32 v229, s60, v229
  v_max_f32 v230, s60, v230
  v_max_f32 v231, s60, v231
  v_pk_add_f32 v[216:217], v[216:217], v[224:225]
  v_pk_add_f32 v[218:219], v[218:219], v[226:227]
  v_pk_add_f32 v[220:221], v[220:221], v[228:229]
  v_pk_add_f32 v[222:223], v[222:223], v[230:231]
  v_cvt_pk_bf16_f32 v128, v216, v217
  v_cvt_pk_bf16_f32 v129, v218, v219
  v_cvt_pk_bf16_f32 v130, v220, v221
  v_cvt_pk_bf16_f32 v131, v222, v223
  v_pk_mul_f32 v[232:233], v[88:89], s[64:65]
  v_pk_mul_f32 v[234:235], v[90:91], s[64:65]
  v_pk_mul_f32 v[236:237], v[92:93], s[64:65]
  v_pk_mul_f32 v[238:239], v[94:95], s[64:65]
  v_pk_add_f32 v[240:241], v[88:89], s[60:61]
  v_pk_add_f32 v[242:243], v[90:91], s[60:61]
  v_pk_add_f32 v[244:245], v[92:93], s[60:61]
  v_pk_add_f32 v[246:247], v[94:95], s[60:61]
  s_add_u32 m0, s53, 49152
  s_nop 0
  buffer_load_dwordx4 v197, s[24:27], s51 offen lds
  buffer_load_dwordx4 v198, s[24:27], s51 offen offset:1024 lds
  s_add_u32 s51, s51, 16384
  s_add_u32 m0, s53, 51200
  s_nop 0
  buffer_load_dwordx4 v197, s[24:27], s51 offen lds
  buffer_load_dwordx4 v198, s[24:27], s51 offen offset:1024 lds
  s_add_u32 s51, s51, 16384
  v_exp_f32 v232, v232 clamp
  v_exp_f32 v233, v233 clamp
  v_exp_f32 v234, v234 clamp
  v_exp_f32 v235, v235 clamp
  v_exp_f32 v236, v236 clamp
  v_exp_f32 v237, v237 clamp
  v_exp_f32 v238, v238 clamp
  v_exp_f32 v239, v239 clamp
  s_waitcnt vmcnt(27)
  ds_read_b64_tr_b16 a[24:25], v199 offset:6144
  ds_read_b64_tr_b16 a[26:27], v199 offset:7168
  ds_read_b64_tr_b16 a[28:29], v200 offset:6144
  ds_read_b64_tr_b16 a[30:31], v200 offset:7168
  s_waitcnt vmcnt(25)
  ds_read_b64_tr_b16 a[32:33], v199 offset:8192
  ds_read_b64_tr_b16 a[34:35], v199 offset:9216
  ds_read_b64_tr_b16 a[36:37], v200 offset:8192
  ds_read_b64_tr_b16 a[38:39], v200 offset:9216
  s_waitcnt vmcnt(23)
  ds_read_b64_tr_b16 a[40:41], v199 offset:10240
  ds_read_b64_tr_b16 a[42:43], v199 offset:11264
  ds_read_b64_tr_b16 a[44:45], v200 offset:10240
  ds_read_b64_tr_b16 a[46:47], v200 offset:11264
  v_max_f32 v240, s60, v240
  v_max_f32 v241, s60, v241
  v_max_f32 v242, s60, v242
  v_max_f32 v243, s60, v243
  v_max_f32 v244, s60, v244
  v_max_f32 v245, s60, v245
  v_max_f32 v246, s60, v246
  v_max_f32 v247, s60, v247
  v_pk_add_f32 v[232:233], v[232:233], v[240:241]
  v_pk_add_f32 v[234:235], v[234:235], v[242:243]
  v_pk_add_f32 v[236:237], v[236:237], v[244:245]
  v_pk_add_f32 v[238:239], v[238:239], v[246:247]
  v_cvt_pk_bf16_f32 v132, v232, v233
  v_cvt_pk_bf16_f32 v133, v234, v235
  v_cvt_pk_bf16_f32 v134, v236, v237
  v_cvt_pk_bf16_f32 v135, v238, v239
  v_pk_mul_f32 v[216:217], v[96:97], s[64:65]
  v_pk_mul_f32 v[218:219], v[98:99], s[64:65]
  v_pk_mul_f32 v[220:221], v[100:101], s[64:65]
  v_pk_mul_f32 v[222:223], v[102:103], s[64:65]
  v_pk_add_f32 v[224:225], v[96:97], s[60:61]
  v_pk_add_f32 v[226:227], v[98:99], s[60:61]
  v_pk_add_f32 v[228:229], v[100:101], s[60:61]
  v_pk_add_f32 v[230:231], v[102:103], s[60:61]
  s_bfe_u32 s69, s48, 0x80018
  s_lshl_b32 s69, s69, 14
  s_add_u32 s51, s69, s100
  s_add_u32 m0, s53, 53248
  s_nop 0
  buffer_load_dwordx4 v197, s[24:27], s51 offen lds
  buffer_load_dwordx4 v198, s[24:27], s51 offen offset:1024 lds
  s_add_u32 s51, s51, 16384
  s_waitcnt lgkmcnt(15)
  s_add_u32 m0, s52, 0
  s_nop 0
  buffer_load_dwordx4 v197, s[24:27], s51 offen lds
  buffer_load_dwordx4 v198, s[24:27], s51 offen offset:1024 lds
  s_add_u32 s51, s51, 16384
  v_exp_f32 v216, v216 clamp
  v_exp_f32 v217, v217 clamp
  v_exp_f32 v218, v218 clamp
  v_exp_f32 v219, v219 clamp
  v_exp_f32 v220, v220 clamp
  v_exp_f32 v221, v221 clamp
  v_exp_f32 v222, v222 clamp
  v_exp_f32 v223, v223 clamp
  s_waitcnt vmcnt(25)
  ds_read_b64_tr_b16 a[48:49], v199 offset:12288
  ds_read_b64_tr_b16 a[50:51], v199 offset:13312
  ds_read_b64_tr_b16 a[52:53], v200 offset:12288
  ds_read_b64_tr_b16 a[54:55], v200 offset:13312
  s_waitcnt vmcnt(23)
  ds_read_b64_tr_b16 a[56:57], v199 offset:14336
  ds_read_b64_tr_b16 a[58:59], v199 offset:15360
  ds_read_b64_tr_b16 a[60:61], v200 offset:14336
  ds_read_b64_tr_b16 a[62:63], v200 offset:15360
  s_waitcnt vmcnt(21)
  ds_read_b64_tr_b16 a[64:65], v201 offset:0
  ds_read_b64_tr_b16 a[66:67], v201 offset:1024
  ds_read_b64_tr_b16 a[68:69], v202 offset:0
  ds_read_b64_tr_b16 a[70:71], v202 offset:1024
  v_max_f32 v224, s60, v224
  v_max_f32 v225, s60, v225
  v_max_f32 v226, s60, v226
  v_max_f32 v227, s60, v227
  v_max_f32 v228, s60, v228
  v_max_f32 v229, s60, v229
  v_max_f32 v230, s60, v230
  v_max_f32 v231, s60, v231
  v_pk_add_f32 v[216:217], v[216:217], v[224:225]
  v_pk_add_f32 v[218:219], v[218:219], v[226:227]
  v_pk_add_f32 v[220:221], v[220:221], v[228:229]
  v_pk_add_f32 v[222:223], v[222:223], v[230:231]
  v_cvt_pk_bf16_f32 v136, v216, v217
  v_cvt_pk_bf16_f32 v137, v218, v219
  v_cvt_pk_bf16_f32 v138, v220, v221
  v_cvt_pk_bf16_f32 v139, v222, v223
  v_pk_mul_f32 v[232:233], v[104:105], s[64:65]
  v_pk_mul_f32 v[234:235], v[106:107], s[64:65]
  v_pk_mul_f32 v[236:237], v[108:109], s[64:65]
  v_pk_mul_f32 v[238:239], v[110:111], s[64:65]
  v_pk_add_f32 v[240:241], v[104:105], s[60:61]
  v_pk_add_f32 v[242:243], v[106:107], s[60:61]
  v_pk_add_f32 v[244:245], v[108:109], s[60:61]
  v_pk_add_f32 v[246:247], v[110:111], s[60:61]
  s_add_u32 m0, s52, 2048
  s_nop 0
  buffer_load_dwordx4 v197, s[24:27], s51 offen lds
  buffer_load_dwordx4 v198, s[24:27], s51 offen offset:1024 lds
  s_add_u32 s51, s51, 16384
  s_waitcnt lgkmcnt(15)
  s_add_u32 m0, s52, 4096
  s_nop 0
  buffer_load_dwordx4 v197, s[24:27], s51 offen lds
  buffer_load_dwordx4 v198, s[24:27], s51 offen offset:1024 lds
  s_add_u32 s51, s51, 16384
  v_exp_f32 v232, v232 clamp
  v_exp_f32 v233, v233 clamp
  v_exp_f32 v234, v234 clamp
  v_exp_f32 v235, v235 clamp
  v_exp_f32 v236, v236 clamp
  v_exp_f32 v237, v237 clamp
  v_exp_f32 v238, v238 clamp
  v_exp_f32 v239, v239 clamp
  s_waitcnt vmcnt(23)
  ds_read_b64_tr_b16 a[72:73], v201 offset:2048
  ds_read_b64_tr_b16 a[74:75], v201 offset:3072
  ds_read_b64_tr_b16 a[76:77], v202 offset:2048
  ds_read_b64_tr_b16 a[78:79], v202 offset:3072
  s_waitcnt vmcnt(21)
  ds_read_b64_tr_b16 a[80:81], v201 offset:4096
  ds_read_b64_tr_b16 a[82:83], v201 offset:5120
  ds_read_b64_tr_b16 a[84:85], v202 offset:4096
  ds_read_b64_tr_b16 a[86:87], v202 offset:5120
  s_waitcnt vmcnt(19)
  ds_read_b64_tr_b16 a[88:89], v201 offset:6144
  ds_read_b64_tr_b16 a[90:91], v201 offset:7168
  ds_read_b64_tr_b16 a[92:93], v202 offset:6144
  ds_read_b64_tr_b16 a[94:95], v202 offset:7168
  v_max_f32 v240, s60, v240
  v_max_f32 v241, s60, v241
  v_max_f32 v242, s60, v242
  v_max_f32 v243, s60, v243
  v_max_f32 v244, s60, v244
  v_max_f32 v245, s60, v245
  v_max_f32 v246, s60, v246
  v_max_f32 v247, s60, v247
  v_pk_add_f32 v[232:233], v[232:233], v[240:241]
  v_pk_add_f32 v[234:235], v[234:235], v[242:243]
  v_pk_add_f32 v[236:237], v[236:237], v[244:245]
  v_pk_add_f32 v[238:239], v[238:239], v[246:247]
  v_cvt_pk_bf16_f32 v140, v232, v233
  v_cvt_pk_bf16_f32 v141, v234, v235
  v_cvt_pk_bf16_f32 v142, v236, v237
  v_cvt_pk_bf16_f32 v143, v238, v239
  v_sub_f32 v166, 1.0, v166
  buffer_load_dwordx3 v[16:18], v123, s[28:31], s3 offen offset:0 sc1
  buffer_load_dwordx3 v[20:22], v123, s[28:31], s3 offen offset:768 sc1
  buffer_load_dwordx3 v[24:26], v123, s[28:31], s3 offen offset:1536 sc1
  buffer_load_dwordx3 v[28:30], v123, s[28:31], s3 offen offset:2304 sc1
  buffer_load_dwordx3 v[32:34], v124, s[28:31], s3 offen offset:0 sc1
  buffer_load_dwordx3 v[36:38], v124, s[28:31], s3 offen offset:768 sc1
  buffer_load_dwordx3 v[40:42], v124, s[28:31], s3 offen offset:1536 sc1
  buffer_load_dwordx3 v[44:46], v124, s[28:31], s3 offen offset:2304 sc1
  buffer_load_dwordx3 v[48:50], v123, s[28:31], s101 offen offset:0 sc1
  buffer_load_dwordx3 v[52:54], v123, s[28:31], s101 offen offset:768 sc1
  buffer_load_dwordx3 v[56:58], v123, s[28:31], s101 offen offset:1536 sc1
  buffer_load_dwordx3 v[60:62], v123, s[28:31], s101 offen offset:2304 sc1
  buffer_load_dwordx3 v[64:66], v124, s[28:31], s101 offen offset:0 sc1
  buffer_load_dwordx3 v[68:70], v124, s[28:31], s101 offen offset:768 sc1
  buffer_load_dwordx3 v[72:74], v124, s[28:31], s101 offen offset:1536 sc1
  buffer_load_dwordx3 v[76:78], v124, s[28:31], s101 offen offset:2304 sc1
  buffer_store_dword v166, v206, s[28:31], s72 offen sc1
  s_bfe_u32 s69, s0, 0x80008
  s_lshl_b32 s69, s69, 14
  s_add_u32 s51, s69, s100
  s_add_u32 m0, s52, 6144
  s_nop 0
  buffer_load_dwordx4 v197, s[24:27], s51 offen lds
  buffer_load_dwordx4 v198, s[24:27], s51 offen offset:1024 lds
  s_add_u32 s51, s51, 16384
  s_add_u32 m0, s52, 8192
  s_nop 0
  buffer_load_dwordx4 v197, s[24:27], s51 offen lds
  buffer_load_dwordx4 v198, s[24:27], s51 offen offset:1024 lds
  s_add_u32 s51, s51, 16384
  s_waitcnt lgkmcnt(15)
  s_add_u32 m0, s52, 10240
  s_nop 0
  buffer_load_dwordx4 v197, s[24:27], s51 offen lds
  buffer_load_dwordx4 v198, s[24:27], s51 offen offset:1024 lds
  s_add_u32 s51, s51, 16384
  s_waitcnt vmcnt(40)
  ds_read_b64_tr_b16 a[96:97], v201 offset:8192
  ds_read_b64_tr_b16 a[98:99], v201 offset:9216
  ds_read_b64_tr_b16 a[100:101], v202 offset:8192
  ds_read_b64_tr_b16 a[102:103], v202 offset:9216
  s_waitcnt vmcnt(37)
  ds_read_b64_tr_b16 a[104:105], v201 offset:45056
  ds_read_b64_tr_b16 a[106:107], v201 offset:46080
  ds_read_b64_tr_b16 a[108:109], v202 offset:45056
  ds_read_b64_tr_b16 a[110:111], v202 offset:46080
  s_waitcnt vmcnt(35)
  ds_read_b64_tr_b16 a[112:113], v201 offset:47104
  ds_read_b64_tr_b16 a[114:115], v201 offset:48128
  ds_read_b64_tr_b16 a[116:117], v202 offset:47104
  ds_read_b64_tr_b16 a[118:119], v202 offset:48128
  s_waitcnt vmcnt(33)
  ds_read_b64_tr_b16 a[120:121], v201 offset:49152
  ds_read_b64_tr_b16 a[122:123], v201 offset:50176
  ds_read_b64_tr_b16 a[124:125], v202 offset:49152
  ds_read_b64_tr_b16 a[126:127], v202 offset:50176
  s_waitcnt vmcnt(31)
  ds_read_b64_tr_b16 a[128:129], v201 offset:51200
  ds_read_b64_tr_b16 a[130:131], v201 offset:52224
  ds_read_b64_tr_b16 a[132:133], v202 offset:51200
  ds_read_b64_tr_b16 a[134:135], v202 offset:52224
  s_waitcnt vmcnt(29)
  ds_read_b64_tr_b16 a[136:137], v201 offset:53248
  ds_read_b64_tr_b16 a[138:139], v201 offset:54272
  ds_read_b64_tr_b16 a[140:141], v202 offset:53248
  ds_read_b64_tr_b16 a[142:143], v202 offset:54272
  s_bfe_u32 s69, s0, 0x80010
  s_lshl_b32 s69, s69, 14
  s_add_u32 s51, s69, s100
  s_add_u32 m0, s52, 12288
  s_nop 0
  buffer_load_dwordx4 v197, s[24:27], s51 offen lds
  buffer_load_dwordx4 v198, s[24:27], s51 offen offset:1024 lds
  s_add_u32 s51, s51, 16384
  s_add_u32 m0, s52, 14336
  s_nop 0
  buffer_load_dwordx4 v197, s[24:27], s51 offen lds
  buffer_load_dwordx4 v198, s[24:27], s51 offen offset:1024 lds
  s_add_u32 s51, s51, 16384
  s_waitcnt lgkmcnt(15)
  s_add_u32 m0, s53, 0
  s_nop 0
  buffer_load_dwordx4 v197, s[24:27], s51 offen lds
  buffer_load_dwordx4 v198, s[24:27], s51 offen offset:1024 lds
  s_add_u32 s51, s51, 16384
  s_waitcnt vmcnt(28)
  v_xor_b32 v9, s55, v18
  s_waitcnt vmcnt(27)
  v_bitop3_b32 v9, s55, v22, v9 bitop3:0xbe
  s_waitcnt vmcnt(26)
  v_bitop3_b32 v9, s55, v26, v9 bitop3:0xbe
  s_waitcnt vmcnt(25)
  v_bitop3_b32 v9, s55, v30, v9 bitop3:0xbe
  s_waitcnt vmcnt(24)
  v_bitop3_b32 v9, s55, v34, v9 bitop3:0xbe
  s_waitcnt vmcnt(23)
  v_bitop3_b32 v9, s55, v38, v9 bitop3:0xbe
  s_waitcnt vmcnt(22)
  v_bitop3_b32 v9, s55, v42, v9 bitop3:0xbe
  s_waitcnt vmcnt(21)
  v_bitop3_b32 v9, s55, v46, v9 bitop3:0xbe
  v_cmp_ne_u16 vcc, 0, v9
  s_nop 4
  s_cbranch_vccz L_ok_11
L_retry_12:
  s_sub_u32 s75, s75, 1
  s_cmp_lt_i32 s75, 0
  s_cbranch_scc1 L_ok_11
  buffer_load_dwordx3 v[16:18], v123, s[28:31], s3 offen offset:0 sc1
  buffer_load_dwordx3 v[20:22], v123, s[28:31], s3 offen offset:768 sc1
  buffer_load_dwordx3 v[24:26], v123, s[28:31], s3 offen offset:1536 sc1
  buffer_load_dwordx3 v[28:30], v123, s[28:31], s3 offen offset:2304 sc1
  buffer_load_dwordx3 v[32:34], v124, s[28:31], s3 offen offset:0 sc1
  buffer_load_dwordx3 v[36:38], v124, s[28:31], s3 offen offset:768 sc1
  buffer_load_dwordx3 v[40:42], v124, s[28:31], s3 offen offset:1536 sc1
  buffer_load_dwordx3 v[44:46], v124, s[28:31], s3 offen offset:2304 sc1
  s_waitcnt vmcnt(0)
  v_xor_b32 v9, s55, v18
  v_bitop3_b32 v9, s55, v22, v9 bitop3:0xbe
  v_bitop3_b32 v9, s55, v26, v9 bitop3:0xbe
  v_bitop3_b32 v9, s55, v30, v9 bitop3:0xbe
  v_bitop3_b32 v9, s55, v34, v9 bitop3:0xbe
  v_bitop3_b32 v9, s55, v38, v9 bitop3:0xbe
  v_bitop3_b32 v9, s55, v42, v9 bitop3:0xbe
  v_bitop3_b32 v9, s55, v46, v9 bitop3:0xbe
  v_cmp_ne_u16 vcc, 0, v9
  s_nop 4
  s_cbranch_vccnz L_retry_12
L_ok_11:
  v_lshlrev_b32 v96, 16, v16
  v_and_b32 v97, s62, v16
  v_lshlrev_b32 v98, 16, v17
  v_and_b32 v99, s62, v17
  v_and_b32 v100, s62, v18
  s_bfe_u32 s69, s0, 0x80018
  s_lshl_b32 s69, s69, 14
  s_add_u32 s51, s69, s100
  s_add_u32 m0, s53, 2048
  s_nop 0
  buffer_load_dwordx4 v197, s[24:27], s51 offen lds
  buffer_load_dwordx4 v198, s[24:27], s51 offen offset:1024 lds
  s_add_u32 s51, s51, 16384
  v_dot2c_f32_bf16 v96, s86, v20
  v_dot2c_f32_bf16 v97, s58, v20
  v_dot2c_f32_bf16 v98, s86, v21
  v_dot2c_f32_bf16 v99, s58, v21
  v_dot2c_f32_bf16 v100, s58, v22
  v_dot2c_f32_bf16 v96, s86, v24
  v_dot2c_f32_bf16 v97, s58, v24
  v_dot2c_f32_bf16 v98, s86, v25
  v_dot2c_f32_bf16 v99, s58, v25
  v_dot2c_f32_bf16 v100, s58, v26
  s_add_u32 m0, s53, 4096
  s_nop 0
  buffer_load_dwordx4 v197, s[24:27], s51 offen lds
  buffer_load_dwordx4 v198, s[24:27], s51 offen offset:1024 lds
  s_add_u32 s51, s51, 16384
  v_dot2c_f32_bf16 v96, s86, v28
  v_dot2c_f32_bf16 v97, s58, v28
  v_dot2c_f32_bf16 v98, s86, v29
  v_dot2c_f32_bf16 v99, s58, v29
  v_dot2c_f32_bf16 v100, s58, v30
  v_dot2c_f32_bf16 v96, s86, v32
  v_dot2c_f32_bf16 v97, s58, v32
  v_dot2c_f32_bf16 v98, s86, v33
  v_dot2c_f32_bf16 v99, s58, v33
  v_dot2c_f32_bf16 v100, s58, v34
  s_add_u32 m0, s53, 6144
  s_nop 0
  buffer_load_dwordx4 v197, s[24:27], s51 offen lds
  buffer_load_dwordx4 v198, s[24:27], s51 offen offset:1024 lds
  s_add_u32 s51, s51, 16384
  v_dot2c_f32_bf16 v96, s86, v36
  v_dot2c_f32_bf16 v97, s58, v36
  v_dot2c_f32_bf16 v98, s86, v37
  v_dot2c_f32_bf16 v99, s58, v37
  v_dot2c_f32_bf16 v100, s58, v38
  v_dot2c_f32_bf16 v96, s86, v40
  v_dot2c_f32_bf16 v97, s58, v40
  v_dot2c_f32_bf16 v98, s86, v41
  v_dot2c_f32_bf16 v99, s58, v41
  v_dot2c_f32_bf16 v100, s58, v42
  s_bfe_u32 s69, s1, 0x80008
  s_lshl_b32 s69, s69, 14
  s_add_u32 s51, s69, s54
  s_add_u32 m0, s53, 8192
  s_nop 0
  buffer_load_dwordx4 v197, s[8:11], s51 offen lds
  buffer_load_dwordx4 v198, s[8:11], s51 offen offset:1024 lds
  s_add_u32 s51, s51, 16384
  v_dot2c_f32_bf16 v96, s86, v44
  v_dot2c_f32_bf16 v97, s58, v44
  v_dot2c_f32_bf16 v98, s86, v45
  v_dot2c_f32_bf16 v99, s58, v45
  v_dot2c_f32_bf16 v100, s58, v46
  s_waitcnt vmcnt(28)
  v_xor_b32 v9, s55, v50
  s_waitcnt vmcnt(27)
  v_bitop3_b32 v9, s55, v54, v9 bitop3:0xbe
  s_waitcnt vmcnt(26)
  v_bitop3_b32 v9, s55, v58, v9 bitop3:0xbe
  s_waitcnt vmcnt(25)
  v_bitop3_b32 v9, s55, v62, v9 bitop3:0xbe
  s_waitcnt vmcnt(24)
  v_bitop3_b32 v9, s55, v66, v9 bitop3:0xbe
  s_waitcnt vmcnt(23)
  v_bitop3_b32 v9, s55, v70, v9 bitop3:0xbe
  s_waitcnt vmcnt(22)
  v_bitop3_b32 v9, s55, v74, v9 bitop3:0xbe
  s_waitcnt vmcnt(21)
  v_bitop3_b32 v9, s55, v78, v9 bitop3:0xbe
  v_cmp_ne_u16 vcc, 0, v9
  s_nop 4
  s_cbranch_vccz L_ok_13
L_retry_14:
  s_sub_u32 s75, s75, 1
  s_cmp_lt_i32 s75, 0
  s_cbranch_scc1 L_ok_13
  buffer_load_dwordx3 v[48:50], v123, s[28:31], s101 offen offset:0 sc1
  buffer_load_dwordx3 v[52:54], v123, s[28:31], s101 offen offset:768 sc1
  buffer_load_dwordx3 v[56:58], v123, s[28:31], s101 offen offset:1536 sc1
  buffer_load_dwordx3 v[60:62], v123, s[28:31], s101 offen offset:2304 sc1
  buffer_load_dwordx3 v[64:66], v124, s[28:31], s101 offen offset:0 sc1
  buffer_load_dwordx3 v[68:70], v124, s[28:31], s101 offen offset:768 sc1
  buffer_load_dwordx3 v[72:74], v124, s[28:31], s101 offen offset:1536 sc1
  buffer_load_dwordx3 v[76:78], v124, s[28:31], s101 offen offset:2304 sc1
  s_waitcnt vmcnt(0)
  v_xor_b32 v9, s55, v50
  v_bitop3_b32 v9, s55, v54, v9 bitop3:0xbe
  v_bitop3_b32 v9, s55, v58, v9 bitop3:0xbe
  v_bitop3_b32 v9, s55, v62, v9 bitop3:0xbe
  v_bitop3_b32 v9, s55, v66, v9 bitop3:0xbe
  v_bitop3_b32 v9, s55, v70, v9 bitop3:0xbe
  v_bitop3_b32 v9, s55, v74, v9 bitop3:0xbe
  v_bitop3_b32 v9, s55, v78, v9 bitop3:0xbe
  v_cmp_ne_u16 vcc, 0, v9
  s_nop 4
  s_cbranch_vccnz L_retry_14
L_ok_13:
  v_dot2c_f32_bf16 v96, s86, v48
  v_dot2c_f32_bf16 v97, s58, v48
  v_dot2c_f32_bf16 v98, s86, v49
  v_dot2c_f32_bf16 v99, s58, v49
  v_dot2c_f32_bf16 v100, s58, v50
  v_dot2c_f32_bf16 v96, s86, v52
  v_dot2c_f32_bf16 v97, s58, v52
  v_dot2c_f32_bf16 v98, s86, v53
  v_dot2c_f32_bf16 v99, s58, v53
  v_dot2c_f32_bf16 v100, s58, v54
  v_dot2c_f32_bf16 v96, s86, v56
  v_dot2c_f32_bf16 v97, s58, v56
  v_dot2c_f32_bf16 v98, s86, v57
  v_dot2c_f32_bf16 v99, s58, v57
  v_dot2c_f32_bf16 v100, s58, v58
  v_dot2c_f32_bf16 v96, s86, v60
  v_dot2c_f32_bf16 v97, s58, v60
  v_dot2c_f32_bf16 v98, s86, v61
  v_dot2c_f32_bf16 v99, s58, v61
  v_dot2c_f32_bf16 v100, s58, v62
  v_dot2c_f32_bf16 v96, s86, v64
  v_dot2c_f32_bf16 v97, s58, v64
  v_dot2c_f32_bf16 v98, s86, v65
  v_dot2c_f32_bf16 v99, s58, v65
  v_dot2c_f32_bf16 v100, s58, v66
  v_dot2c_f32_bf16 v96, s86, v68
  v_dot2c_f32_bf16 v97, s58, v68
  v_dot2c_f32_bf16 v98, s86, v69
  v_dot2c_f32_bf16 v99, s58, v69
  v_dot2c_f32_bf16 v100, s58, v70
  v_dot2c_f32_bf16 v96, s86, v72
  v_dot2c_f32_bf16 v97, s58, v72
  v_dot2c_f32_bf16 v98, s86, v73
  v_dot2c_f32_bf16 v99, s58, v73
  v_dot2c_f32_bf16 v100, s58, v74
  v_dot2c_f32_bf16 v96, s86, v76
  v_dot2c_f32_bf16 v97, s58, v76
  v_dot2c_f32_bf16 v98, s86, v77
  v_dot2c_f32_bf16 v99, s58, v77
  v_dot2c_f32_bf16 v100, s58, v78
  s_add_u32 s85, s94, 131072
  buffer_load_dword v204, v203, s[28:31], s85 offen sc1
  v_cvt_pk_bf16_f32 v96, v96, v97
  v_cvt_pk_bf16_f32 v97, v98, v99
  v_cvt_pk_bf16_f32 v100, v100, v100
  ds_write_b64 v125, v[96:97]
  s_mov_b64 exec, 0xffff
  ds_write_b16 v126, v100
  s_mov_b64 exec, -1
  s_waitcnt lgkmcnt(0)
  s_barrier
  ds_read_b128 v[144:147], v127
  ds_read_b128 v[148:151], v127 offset:576
  s_waitcnt lgkmcnt(1)
  v_mfma_f32_32x32x16_bf16 v[16:31], v[144:147], v[128:131], 0
  s_waitcnt lgkmcnt(0)
  v_mfma_f32_32x32x16_bf16 v[32:47], v[148:151], v[132:135], 0
  v_mfma_f32_32x32x16_bf16 v[48:63], v[144:147], v[136:139], 0
  v_mfma_f32_32x32x16_bf16 v[64:79], v[148:151], v[140:143], 0
  v_add_f32 v24, s60, v24
  v_rcp_f32 v24, v24
  s_nop 0
  v_mul_f32 v24, v24, v164
  v_pk_mul_f32 v[16:17], v[16:17], v[24:25] op_sel_hi:[1,0]
  v_pk_mul_f32 v[18:19], v[18:19], v[24:25] op_sel_hi:[1,0]
  v_pk_mul_f32 v[20:21], v[20:21], v[24:25] op_sel_hi:[1,0]
  v_pk_mul_f32 v[22:23], v[22:23], v[24:25] op_sel_hi:[1,0]
  v_cvt_pk_bf16_f32 v216, v16, v17
  v_cvt_pk_bf16_f32 v217, v18, v19
  v_cvt_pk_bf16_f32 v218, v20, v21
  v_cvt_pk_bf16_f32 v219, v22, v23
  buffer_store_dwordx4 v[216:219], v2, s[28:31], s70 offen offset:0 sc1
  v_add_f32 v40, s60, v40
  v_rcp_f32 v40, v40
  s_nop 0
  v_mul_f32 v40, v40, v164
  v_pk_mul_f32 v[32:33], v[32:33], v[40:41] op_sel_hi:[1,0]
  v_pk_mul_f32 v[34:35], v[34:35], v[40:41] op_sel_hi:[1,0]
  v_pk_mul_f32 v[36:37], v[36:37], v[40:41] op_sel_hi:[1,0]
  v_pk_mul_f32 v[38:39], v[38:39], v[40:41] op_sel_hi:[1,0]
  v_cvt_pk_bf16_f32 v220, v32, v33
  v_cvt_pk_bf16_f32 v221, v34, v35
  v_cvt_pk_bf16_f32 v222, v36, v37
  v_cvt_pk_bf16_f32 v223, v38, v39
  buffer_store_dwordx4 v[220:223], v2, s[28:31], s70 offen offset:1024 sc1
  v_add_f32 v56, s60, v56
  v_rcp_f32 v56, v56
  s_nop 0
  v_mul_f32 v56, v56, v165
  v_pk_mul_f32 v[48:49], v[48:49], v[56:57] op_sel_hi:[1,0]
  v_pk_mul_f32 v[50:51], v[50:51], v[56:57] op_sel_hi:[1,0]
  v_pk_mul_f32 v[52:53], v[52:53], v[56:57] op_sel_hi:[1,0]
  v_pk_mul_f32 v[54:55], v[54:55], v[56:57] op_sel_hi:[1,0]
  v_cvt_pk_bf16_f32 v224, v48, v49
  v_cvt_pk_bf16_f32 v225, v50, v51
  v_cvt_pk_bf16_f32 v226, v52, v53
  v_cvt_pk_bf16_f32 v227, v54, v55
  buffer_store_dwordx4 v[224:227], v2, s[28:31], s71 offen offset:0 sc1
  v_add_f32 v72, s60, v72
  v_rcp_f32 v72, v72
  s_nop 0
  v_mul_f32 v72, v72, v165
  v_pk_mul_f32 v[64:65], v[64:65], v[72:73] op_sel_hi:[1,0]
  v_pk_mul_f32 v[66:67], v[66:67], v[72:73] op_sel_hi:[1,0]
  v_pk_mul_f32 v[68:69], v[68:69], v[72:73] op_sel_hi:[1,0]
  v_pk_mul_f32 v[70:71], v[70:71], v[72:73] op_sel_hi:[1,0]
  v_cvt_pk_bf16_f32 v228, v64, v65
  v_cvt_pk_bf16_f32 v229, v66, v67
  v_cvt_pk_bf16_f32 v230, v68, v69
  v_cvt_pk_bf16_f32 v231, v70, v71
  buffer_store_dwordx4 v[228:231], v2, s[28:31], s71 offen offset:1024 sc1
  s_add_u32 m0, s53, 45056
  s_nop 0
  buffer_load_dwordx4 v197, s[8:11], s51 offen lds
  buffer_load_dwordx4 v198, s[8:11], s51 offen offset:1024 lds
  s_add_u32 s51, s51, 16384
  s_bfe_u32 s69, s1, 0x80010
  s_lshl_b32 s69, s69, 14
  s_add_u32 s51, s69, s54
  s_add_u32 m0, s53, 47104
  s_nop 0
  buffer_load_dwordx4 v197, s[8:11], s51 offen lds
  buffer_load_dwordx4 v198, s[8:11], s51 offen offset:1024 lds
  s_add_u32 s51, s51, 16384
  s_add_u32 m0, s53, 49152
  s_nop 0
  buffer_load_dwordx4 v197, s[8:11], s51 offen lds
  buffer_load_dwordx4 v198, s[8:11], s51 offen offset:1024 lds
  s_add_u32 s51, s51, 16384
  s_bfe_u32 s69, s1, 0x80018
  s_lshl_b32 s69, s69, 14
  s_add_u32 s51, s69, s54
  s_add_u32 m0, s53, 51200
  s_nop 0
  buffer_load_dwordx4 v197, s[8:11], s51 offen lds
  buffer_load_dwordx4 v198, s[8:11], s51 offen offset:1024 lds
  s_add_u32 s51, s51, 16384
  s_add_u32 m0, s53, 53248
  s_nop 0
  buffer_load_dwordx4 v197, s[8:11], s51 offen lds
  buffer_load_dwordx4 v198, s[8:11], s51 offen offset:1024 lds
  s_add_u32 s51, s51, 16384
  s_mul_i32 s66, s36, 20480
  s_add_u32 s84, s96, s66
  s_sub_u32 s84, s84, 114688
  s_waitcnt vmcnt(14)
  v_cmp_ne_u32 vcc, s50, v204
  s_nop 4
  s_cbranch_vccz L_ok_15
L_retry_16:
  s_sub_u32 s75, s75, 1
  s_cmp_lt_i32 s75, 0
  s_cbranch_scc1 L_ok_15
  buffer_load_dword v204, v203, s[28:31], s85 offen sc1
  s_waitcnt vmcnt(0)
  v_cmp_ne_u32 vcc, s50, v204
  s_nop 4
  s_cbranch_vccnz L_retry_16
L_ok_15:
  s_bfe_u32 s68, s48, 0x80000
  s_lshl_b32 s68, s68, 10
  s_add_u32 s73, s68, s84
  buffer_load_dwordx4 a[144:147], v2, s[28:31], s73 offen offset:0 sc1
  s_add_u32 s74, s73, 147456
  buffer_load_dwordx4 a[148:151], v2, s[28:31], s74 offen offset:0 sc1
  buffer_load_dwordx4 a[152:155], v2, s[28:31], s73 offen offset:1024 sc1
  buffer_load_dwordx4 a[156:159], v2, s[28:31], s74 offen offset:1024 sc1
  buffer_load_dwordx4 a[160:163], v2, s[28:31], s73 offen offset:2048 sc1
  buffer_load_dwordx4 a[164:167], v2, s[28:31], s74 offen offset:2048 sc1
  s_waitcnt vmcnt(16)
  s_mov_b64 exec, 1
  buffer_store_dword v205, v3, s[28:31], s93 offen sc1
  s_mov_b64 exec, -1
  buffer_load_dwordx4 a[168:171], v2, s[28:31], s73 offen offset:3072 sc1
  buffer_load_dwordx4 a[172:175], v2, s[28:31], s74 offen offset:3072 sc1
  s_bfe_u32 s68, s48, 0x80008
  s_lshl_b32 s68, s68, 10
  s_add_u32 s73, s68, s84
  buffer_load_dwordx4 a[176:179], v2, s[28:31], s73 offen offset:0 sc1
  s_add_u32 s74, s73, 147456
  buffer_load_dwordx4 a[180:183], v2, s[28:31], s74 offen offset:0 sc1
  buffer_load_dwordx4 a[184:187], v2, s[28:31], s73 offen offset:1024 sc1
  buffer_load_dwordx4 a[188:191], v2, s[28:31], s74 offen offset:1024 sc1
  buffer_load_dwordx4 a[192:195], v2, s[28:31], s73 offen offset:2048 sc1
  buffer_load_dwordx4 a[196:199], v2, s[28:31], s74 offen offset:2048 sc1
  buffer_load_dwordx4 a[200:203], v2, s[28:31], s73 offen offset:3072 sc1
  buffer_load_dwordx4 a[204:207], v2, s[28:31], s74 offen offset:3072 sc1
  s_waitcnt vmcnt(16)
  v_mfma_f32_32x32x16_bf16 v[16:31], a[144:147], a[0:3], 0
  v_mfma_f32_32x32x16_bf16 v[32:47], a[144:147], a[4:7], 0
  s_bfe_u32 s68, s48, 0x80010
  s_lshl_b32 s68, s68, 10
  s_add_u32 s73, s68, s84
  buffer_load_dwordx4 a[208:211], v2, s[28:31], s73 offen offset:0 sc1
  s_waitcnt vmcnt(16)
  v_mfma_f32_32x32x16_bf16 v[48:63], a[148:151], a[0:3], 0
  v_mfma_f32_32x32x16_bf16 v[64:79], a[148:151], a[4:7], 0
  s_add_u32 s74, s73, 147456
  buffer_load_dwordx4 a[212:215], v2, s[28:31], s74 offen offset:0 sc1
  s_waitcnt vmcnt(16)
  v_mfma_f32_32x32x16_bf16 v[16:31], a[152:155], a[8:11], v[16:31]
  v_mfma_f32_32x32x16_bf16 v[32:47], a[152:155], a[12:15], v[32:47]
  buffer_load_dwordx4 a[216:219], v2, s[28:31], s73 offen offset:1024 sc1
  s_waitcnt vmcnt(16)
  v_mfma_f32_32x32x16_bf16 v[48:63], a[156:159], a[8:11], v[48:63]
  v_mfma_f32_32x32x16_bf16 v[64:79], a[156:159], a[12:15], v[64:79]
  buffer_load_dwordx4 a[220:223], v2, s[28:31], s74 offen offset:1024 sc1
  buffer_load_dword v204, v203, s[28:31], s94 offen sc1
  s_waitcnt vmcnt(17)
  v_mfma_f32_32x32x16_bf16 v[16:31], a[160:163], a[16:19], v[16:31]
  v_mfma_f32_32x32x16_bf16 v[32:47], a[160:163], a[20:23], v[32:47]
  buffer_load_dwordx4 a[224:227], v2, s[28:31], s73 offen offset:2048 sc1
  s_waitcnt vmcnt(17)
  v_mfma_f32_32x32x16_bf16 v[48:63], a[164:167], a[16:19], v[48:63]
  v_mfma_f32_32x32x16_bf16 v[64:79], a[164:167], a[20:23], v[64:79]
  buffer_load_dwordx4 a[228:231], v2, s[28:31], s74 offen offset:2048 sc1
  s_waitcnt vmcnt(16)
  v_mfma_f32_32x32x16_bf16 v[16:31], a[168:171], a[24:27], v[16:31]
  v_mfma_f32_32x32x16_bf16 v[32:47], a[168:171], a[28:31], v[32:47]
  buffer_load_dwordx4 a[232:235], v2, s[28:31], s73 offen offset:3072 sc1
  s_waitcnt vmcnt(16)
  v_mfma_f32_32x32x16_bf16 v[48:63], a[172:175], a[24:27], v[48:63]
  v_mfma_f32_32x32x16_bf16 v[64:79], a[172:175], a[28:31], v[64:79]
  buffer_load_dwordx4 a[236:239], v2, s[28:31], s74 offen offset:3072 sc1
  s_waitcnt vmcnt(16)
  v_mfma_f32_32x32x16_bf16 v[16:31], a[176:179], a[72:75], v[16:31]
  v_mfma_f32_32x32x16_bf16 v[32:47], a[176:179], a[76:79], v[32:47]
  s_bfe_u32 s68, s48, 0x80018
  s_lshl_b32 s68, s68, 10
  s_add_u32 s73, s68, s84
  buffer_load_dwordx4 a[240:243], v2, s[28:31], s73 offen offset:0 sc1
  s_waitcnt vmcnt(16)
  v_mfma_f32_32x32x16_bf16 v[48:63], a[180:183], a[72:75], v[48:63]
  v_mfma_f32_32x32x16_bf16 v[64:79], a[180:183], a[76:79], v[64:79]
  s_add_u32 s74, s73, 147456
  buffer_load_dwordx4 a[244:247], v2, s[28:31], s74 offen offset:0 sc1
  s_waitcnt vmcnt(16)
  v_mfma_f32_32x32x16_bf16 v[16:31], a[184:187], a[80:83], v[16:31]
  v_mfma_f32_32x32x16_bf16 v[32:47], a[184:187], a[84:87], v[32:47]
  buffer_load_dwordx4 a[248:251], v2, s[28:31], s73 offen offset:1024 sc1
  s_waitcnt vmcnt(16)
  v_mfma_f32_32x32x16_bf16 v[48:63], a[188:191], a[80:83], v[48:63]
  v_mfma_f32_32x32x16_bf16 v[64:79], a[188:191], a[84:87], v[64:79]
  buffer_load_dwordx4 a[252:255], v2, s[28:31], s74 offen offset:1024 sc1
  s_waitcnt vmcnt(16)
  v_mfma_f32_32x32x16_bf16 v[16:31], a[192:195], a[88:91], v[16:31]
  v_mfma_f32_32x32x16_bf16 v[32:47], a[192:195], a[92:95], v[32:47]
  buffer_load_dwordx4 a[144:147], v2, s[28:31], s73 offen offset:2048 sc1
  s_waitcnt vmcnt(16)
  v_mfma_f32_32x32x16_bf16 v[48:63], a[196:199], a[88:91], v[48:63]
  v_mfma_f32_32x32x16_bf16 v[64:79], a[196:199], a[92:95], v[64:79]
  buffer_load_dwordx4 a[148:151], v2, s[28:31], s74 offen offset:2048 sc1
  s_waitcnt vmcnt(16)
  v_mfma_f32_32x32x16_bf16 v[16:31], a[200:203], a[96:99], v[16:31]
  s_waitcnt vmcnt(10)
  v_cmp_ne_u32 vcc, s50, v204
  s_nop 4
  s_cbranch_vccz L_ok_17
L_retry_18:
  s_sub_u32 s75, s75, 1
  s_cmp_lt_i32 s75, 0
  s_cbranch_scc1 L_ok_17
  buffer_load_dword v204, v203, s[28:31], s94 offen sc1
  s_waitcnt vmcnt(0)
  v_cmp_ne_u32 vcc, s50, v204
  s_nop 4
  s_cbranch_vccnz L_retry_18
L_ok_17:
  v_mfma_f32_32x32x16_bf16 v[32:47], a[200:203], a[100:103], v[32:47]
  buffer_load_dwordx4 a[152:155], v2, s[28:31], s73 offen offset:3072 sc1
  v_mfma_f32_32x32x16_bf16 v[48:63], a[204:207], a[96:99], v[48:63]
  v_mfma_f32_32x32x16_bf16 v[64:79], a[204:207], a[100:103], v[64:79]
  buffer_load_dwordx4 a[156:159], v2, s[28:31], s74 offen offset:3072 sc1
  v_mfma_f32_32x32x16_bf16 v[16:31], a[208:211], a[104:107], v[16:31]
  v_mfma_f32_32x32x16_bf16 v[32:47], a[208:211], a[108:111], v[32:47]
  s_bfe_u32 s68, s0, 0x80000
  s_lshl_b32 s68, s68, 10
  s_add_u32 s73, s68, s84
  buffer_load_dwordx4 a[160:163], v2, s[28:31], s73 offen offset:0 sc1
  v_mfma_f32_32x32x16_bf16 v[48:63], a[212:215], a[104:107], v[48:63]
  v_mfma_f32_32x32x16_bf16 v[64:79], a[212:215], a[108:111], v[64:79]
  s_add_u32 s74, s73, 147456
  buffer_load_dwordx4 a[164:167], v2, s[28:31], s74 offen offset:0 sc1
  v_mfma_f32_32x32x16_bf16 v[16:31], a[216:219], a[112:115], v[16:31]
  v_mfma_f32_32x32x16_bf16 v[32:47], a[216:219], a[116:119], v[32:47]
  buffer_load_dwordx4 a[168:171], v2, s[28:31], s73 offen offset:1024 sc1
  v_mfma_f32_32x32x16_bf16 v[48:63], a[220:223], a[112:115], v[48:63]
  v_mfma_f32_32x32x16_bf16 v[64:79], a[220:223], a[116:119], v[64:79]
  buffer_load_dwordx4 a[172:175], v2, s[28:31], s74 offen offset:1024 sc1
  s_waitcnt vmcnt(15)
  v_mfma_f32_32x32x16_bf16 v[16:31], a[224:227], a[120:123], v[16:31]
  v_mfma_f32_32x32x16_bf16 v[32:47], a[224:227], a[124:127], v[32:47]
  buffer_load_dwordx4 a[176:179], v2, s[28:31], s73 offen offset:2048 sc1
  s_waitcnt vmcnt(15)
  v_mfma_f32_32x32x16_bf16 v[48:63], a[228:231], a[120:123], v[48:63]
  v_mfma_f32_32x32x16_bf16 v[64:79], a[228:231], a[124:127], v[64:79]
  buffer_load_dwordx4 a[180:183], v2, s[28:31], s74 offen offset:2048 sc1
  s_waitcnt vmcnt(15)
  v_mfma_f32_32x32x16_bf16 v[16:31], a[232:235], a[128:131], v[16:31]
  v_mfma_f32_32x32x16_bf16 v[32:47], a[232:235], a[132:135], v[32:47]
  s_bfe_u32 s68, s0, 0x80008
  s_lshl_b32 s68, s68, 10
  s_add_u32 s73, s68, s84
  buffer_load_dwordx4 a[184:187], v2, s[28:31], s73 offen offset:0 sc1
  s_waitcnt vmcnt(15)
  v_mfma_f32_32x32x16_bf16 v[48:63], a[236:239], a[128:131], v[48:63]
  v_mfma_f32_32x32x16_bf16 v[64:79], a[236:239], a[132:135], v[64:79]
  s_add_u32 s74, s73, 147456
  buffer_load_dwordx4 a[188:191], v2, s[28:31], s74 offen offset:0 sc1
  s_waitcnt vmcnt(15)
  v_mfma_f32_32x32x16_bf16 v[16:31], a[240:243], a[136:139], v[16:31]
  ds_read_b64_tr_b16 v[152:153], v199 offset:0
  ds_read_b64_tr_b16 v[154:155], v199 offset:1024
  v_mfma_f32_32x32x16_bf16 v[32:47], a[240:243], a[140:143], v[32:47]
  ds_read_b64_tr_b16 v[156:157], v200 offset:0
  ds_read_b64_tr_b16 v[158:159], v200 offset:1024
  buffer_load_dwordx4 a[192:195], v2, s[28:31], s73 offen offset:1024 sc1
  s_waitcnt vmcnt(15)
  v_mfma_f32_32x32x16_bf16 v[48:63], a[244:247], a[136:139], v[48:63]
  v_mfma_f32_32x32x16_bf16 v[64:79], a[244:247], a[140:143], v[64:79]
  buffer_load_dwordx4 a[196:199], v2, s[28:31], s74 offen offset:1024 sc1
  buffer_load_dword v204, v203, s[28:31], s95 offen sc1
  s_waitcnt vmcnt(16) lgkmcnt(2)
  v_mfma_f32_32x32x16_bf16 v[16:31], a[248:251], v[152:155], v[16:31]
  ds_read_b64_tr_b16 v[144:145], v199 offset:2048
  ds_read_b64_tr_b16 v[146:147], v199 offset:3072
  s_waitcnt lgkmcnt(2)
  v_mfma_f32_32x32x16_bf16 v[32:47], a[248:251], v[156:159], v[32:47]
  ds_read_b64_tr_b16 v[148:149], v200 offset:2048
  ds_read_b64_tr_b16 v[150:151], v200 offset:3072
  buffer_load_dwordx4 a[200:203], v2, s[28:31], s73 offen offset:2048 sc1
  s_waitcnt vmcnt(16)
  v_mfma_f32_32x32x16_bf16 v[48:63], a[252:255], v[152:155], v[48:63]
  v_mfma_f32_32x32x16_bf16 v[64:79], a[252:255], v[156:159], v[64:79]
  buffer_load_dwordx4 a[204:207], v2, s[28:31], s74 offen offset:2048 sc1
  s_waitcnt vmcnt(16) lgkmcnt(2)
  v_mfma_f32_32x32x16_bf16 v[16:31], a[144:147], v[144:147], v[16:31]
  ds_read_b64_tr_b16 v[152:153], v199 offset:4096
  ds_read_b64_tr_b16 v[154:155], v199 offset:5120
  s_waitcnt lgkmcnt(2)
  v_mfma_f32_32x32x16_bf16 v[32:47], a[144:147], v[148:151], v[32:47]
  ds_read_b64_tr_b16 v[156:157], v200 offset:4096
  ds_read_b64_tr_b16 v[158:159], v200 offset:5120
  s_bfe_u32 s68, s0, 0x80010
  s_lshl_b32 s68, s68, 10
  s_add_u32 s73, s68, s84
  buffer_load_dwordx4 a[208:211], v2, s[28:31], s73 offen offset:0 sc1
  s_waitcnt vmcnt(16)
  v_mfma_f32_32x32x16_bf16 v[48:63], a[148:151], v[144:147], v[48:63]
  v_mfma_f32_32x32x16_bf16 v[64:79], a[148:151], v[148:151], v[64:79]
  s_add_u32 s74, s73, 147456
  buffer_load_dwordx4 a[212:215], v2, s[28:31], s74 offen offset:0 sc1
  s_waitcnt vmcnt(16) lgkmcnt(2)
  v_mfma_f32_32x32x16_bf16 v[16:31], a[152:155], v[152:155], v[16:31]
  s_waitcnt lgkmcnt(0)
  v_mfma_f32_32x32x16_bf16 v[32:47], a[152:155], v[156:159], v[32:47]
  buffer_load_dwordx4 a[216:219], v2, s[28:31], s73 offen offset:1024 sc1
  s_waitcnt vmcnt(16)
  v_mfma_f32_32x32x16_bf16 v[48:63], a[156:159], v[152:155], v[48:63]
  v_mfma_f32_32x32x16_bf16 v[64:79], a[156:159], v[156:159], v[64:79]
  buffer_load_dwordx4 a[220:223], v2, s[28:31], s74 offen offset:1024 sc1
  s_waitcnt vmcnt(16)
  v_mfma_f32_32x32x16_bf16 v[16:31], a[160:163], a[32:35], v[16:31]
  v_mfma_f32_32x32x16_bf16 v[32:47], a[160:163], a[36:39], v[32:47]
  buffer_load_dwordx4 a[224:227], v2, s[28:31], s73 offen offset:2048 sc1
  s_waitcnt vmcnt(16)
  v_mfma_f32_32x32x16_bf16 v[48:63], a[164:167], a[32:35], v[48:63]
  v_mfma_f32_32x32x16_bf16 v[64:79], a[164:167], a[36:39], v[64:79]
  buffer_load_dwordx4 a[228:231], v2, s[28:31], s74 offen offset:2048 sc1
  s_waitcnt vmcnt(16)
  v_mfma_f32_32x32x16_bf16 v[16:31], a[168:171], a[40:43], v[16:31]
  v_mfma_f32_32x32x16_bf16 v[32:47], a[168:171], a[44:47], v[32:47]
  s_bfe_u32 s68, s0, 0x80018
  s_lshl_b32 s68, s68, 10
  s_add_u32 s73, s68, s84
  buffer_load_dwordx4 a[232:235], v2, s[28:31], s73 offen offset:0 sc1
  s_waitcnt vmcnt(16)
  v_mfma_f32_32x32x16_bf16 v[48:63], a[172:175], a[40:43], v[48:63]
  v_mfma_f32_32x32x16_bf16 v[64:79], a[172:175], a[44:47], v[64:79]
  s_add_u32 s74, s73, 147456
  buffer_load_dwordx4 a[236:239], v2, s[28:31], s74 offen offset:0 sc1
  s_waitcnt vmcnt(16)
  v_mfma_f32_32x32x16_bf16 v[16:31], a[176:179], a[48:51], v[16:31]
  ds_read_b64_tr_b16 v[152:153], v199 offset:6144
  ds_read_b64_tr_b16 v[154:155], v199 offset:7168
  v_mfma_f32_32x32x16_bf16 v[32:47], a[176:179], a[52:55], v[32:47]
  ds_read_b64_tr_b16 v[156:157], v200 offset:6144
  ds_read_b64_tr_b16 v[158:159], v200 offset:7168
  buffer_load_dwordx4 a[240:243], v2, s[28:31], s73 offen offset:1024 sc1
  s_waitcnt vmcnt(16)
  v_mfma_f32_32x32x16_bf16 v[48:63], a[180:183], a[48:51], v[48:63]
  v_mfma_f32_32x32x16_bf16 v[64:79], a[180:183], a[52:55], v[64:79]
  buffer_load_dwordx4 a[244:247], v2, s[28:31], s74 offen offset:1024 sc1
  s_waitcnt vmcnt(16) lgkmcnt(2)
  v_mfma_f32_32x32x16_bf16 v[16:31], a[184:187], v[152:155], v[16:31]
  ds_read_b64_tr_b16 v[144:145], v199 offset:8192
  ds_read_b64_tr_b16 v[146:147], v199 offset:9216
  s_waitcnt lgkmcnt(2)
  v_mfma_f32_32x32x16_bf16 v[32:47], a[184:187], v[156:159], v[32:47]
  ds_read_b64_tr_b16 v[148:149], v200 offset:8192
  ds_read_b64_tr_b16 v[150:151], v200 offset:9216
  buffer_load_dwordx4 a[248:251], v2, s[28:31], s73 offen offset:2048 sc1
  s_waitcnt vmcnt(16)
  v_mfma_f32_32x32x16_bf16 v[48:63], a[188:191], v[152:155], v[48:63]
  v_mfma_f32_32x32x16_bf16 v[64:79], a[188:191], v[156:159], v[64:79]
  buffer_load_dwordx4 a[252:255], v2, s[28:31], s74 offen offset:2048 sc1
  s_waitcnt vmcnt(16) lgkmcnt(2)
  v_mfma_f32_32x32x16_bf16 v[16:31], a[192:195], v[144:147], v[16:31]
  ds_read_b64_tr_b16 v[152:153], v199 offset:10240
  ds_read_b64_tr_b16 v[154:155], v199 offset:11264
  s_waitcnt vmcnt(14)
  v_cmp_ne_u32 vcc, s50, v204
  s_nop 4
  s_cbranch_vccz L_ok_19
L_retry_20:
  s_sub_u32 s75, s75, 1
  s_cmp_lt_i32 s75, 0
  s_cbranch_scc1 L_ok_19
  buffer_load_dword v204, v203, s[28:31], s95 offen sc1
  s_waitcnt vmcnt(0)
  v_cmp_ne_u32 vcc, s50, v204
  s_nop 4
  s_cbranch_vccnz L_retry_20
L_ok_19:
  buffer_load_dword v209, v206, s[28:31], s97 offen sc1
  s_waitcnt lgkmcnt(2)
  v_mfma_f32_32x32x16_bf16 v[32:47], a[192:195], v[148:151], v[32:47]
  ds_read_b64_tr_b16 v[156:157], v200 offset:10240
  ds_read_b64_tr_b16 v[158:159], v200 offset:11264
  s_bfe_u32 s68, s1, 0x80000
  s_lshl_b32 s68, s68, 10
  s_add_u32 s73, s68, s96
  buffer_load_dwordx4 a[144:147], v2, s[28:31], s73 offen offset:0 sc1
  v_mfma_f32_32x32x16_bf16 v[48:63], a[196:199], v[144:147], v[48:63]
  v_mfma_f32_32x32x16_bf16 v[64:79], a[196:199], v[148:151], v[64:79]
  s_add_u32 s74, s73, 147456
  buffer_load_dwordx4 a[148:151], v2, s[28:31], s74 offen offset:0 sc1
  s_waitcnt vmcnt(16) lgkmcnt(2)
  v_mfma_f32_32x32x16_bf16 v[16:31], a[200:203], v[152:155], v[16:31]
  ds_read_b64_tr_b16 v[144:145], v199 offset:12288
  ds_read_b64_tr_b16 v[146:147], v199 offset:13312
  s_waitcnt lgkmcnt(2)
  v_mfma_f32_32x32x16_bf16 v[32:47], a[200:203], v[156:159], v[32:47]
  ds_read_b64_tr_b16 v[148:149], v200 offset:12288
  ds_read_b64_tr_b16 v[150:151], v200 offset:13312
  buffer_load_dwordx4 a[152:155], v2, s[28:31], s73 offen offset:1024 sc1
  s_waitcnt vmcnt(16)
  v_mfma_f32_32x32x16_bf16 v[48:63], a[204:207], v[152:155], v[48:63]
  v_mfma_f32_32x32x16_bf16 v[64:79], a[204:207], v[156:159], v[64:79]
  buffer_load_dwordx4 a[156:159], v2, s[28:31], s74 offen offset:1024 sc1
  s_waitcnt vmcnt(16) lgkmcnt(2)
  v_mfma_f32_32x32x16_bf16 v[16:31], a[208:211], v[144:147], v[16:31]
  ds_read_b64_tr_b16 v[152:153], v199 offset:14336
  ds_read_b64_tr_b16 v[154:155], v199 offset:15360
  s_waitcnt lgkmcnt(2)
  v_mfma_f32_32x32x16_bf16 v[32:47], a[208:211], v[148:151], v[32:47]
  ds_read_b64_tr_b16 v[156:157], v200 offset:14336
  ds_read_b64_tr_b16 v[158:159], v200 offset:15360
  s_bfe_u32 s68, s1, 0x80008
  s_lshl_b32 s68, s68, 10
  s_add_u32 s73, s68, s96
  buffer_load_dwordx4 a[160:163], v2, s[28:31], s73 offen offset:0 sc1
  s_waitcnt vmcnt(16)
  v_mfma_f32_32x32x16_bf16 v[48:63], a[212:215], v[144:147], v[48:63]
  v_mfma_f32_32x32x16_bf16 v[64:79], a[212:215], v[148:151], v[64:79]
  s_add_u32 s74, s73, 147456
  buffer_load_dwordx4 a[164:167], v2, s[28:31], s74 offen offset:0 sc1
  s_waitcnt vmcnt(16) lgkmcnt(2)
  v_mfma_f32_32x32x16_bf16 v[16:31], a[216:219], v[152:155], v[16:31]
  ds_read_b64_tr_b16 v[144:145], v201 offset:0
  ds_read_b64_tr_b16 v[146:147], v201 offset:1024
  s_waitcnt lgkmcnt(2)
  v_mfma_f32_32x32x16_bf16 v[32:47], a[216:219], v[156:159], v[32:47]
  ds_read_b64_tr_b16 v[148:149], v202 offset:0
  ds_read_b64_tr_b16 v[150:151], v202 offset:1024
  buffer_load_dwordx4 a[168:171], v2, s[28:31], s73 offen offset:1024 sc1
  s_waitcnt vmcnt(16)
  v_mfma_f32_32x32x16_bf16 v[48:63], a[220:223], v[152:155], v[48:63]
  v_mfma_f32_32x32x16_bf16 v[64:79], a[220:223], v[156:159], v[64:79]
  buffer_load_dwordx4 a[172:175], v2, s[28:31], s74 offen offset:1024 sc1
  s_waitcnt vmcnt(16) lgkmcnt(2)
  v_mfma_f32_32x32x16_bf16 v[16:31], a[224:227], v[144:147], v[16:31]
  ds_read_b64_tr_b16 v[152:153], v201 offset:2048
  ds_read_b64_tr_b16 v[154:155], v201 offset:3072
  s_waitcnt lgkmcnt(2)
  v_mfma_f32_32x32x16_bf16 v[32:47], a[224:227], v[148:151], v[32:47]
  ds_read_b64_tr_b16 v[156:157], v202 offset:2048
  ds_read_b64_tr_b16 v[158:159], v202 offset:3072
  s_bfe_u32 s68, s1, 0x80010
  s_lshl_b32 s68, s68, 10
  s_add_u32 s73, s68, s96
  buffer_load_dwordx4 a[176:179], v2, s[28:31], s73 offen offset:0 sc1
  s_waitcnt vmcnt(16)
  v_mfma_f32_32x32x16_bf16 v[48:63], a[228:231], v[144:147], v[48:63]
  s_waitcnt vmcnt(9)
  ds_write_b32 v207, v209
  v_mfma_f32_32x32x16_bf16 v[64:79], a[228:231], v[148:151], v[64:79]
  s_add_u32 s74, s73, 147456
  buffer_load_dwordx4 a[180:183], v2, s[28:31], s74 offen offset:0 sc1
  s_waitcnt lgkmcnt(3)
  v_mfma_f32_32x32x16_bf16 v[16:31], a[232:235], v[152:155], v[16:31]
  ds_read_b64_tr_b16 v[144:145], v201 offset:4096
  ds_read_b64_tr_b16 v[146:147], v201 offset:5120
  s_waitcnt lgkmcnt(3)
  v_mfma_f32_32x32x16_bf16 v[32:47], a[232:235], v[156:159], v[32:47]
  ds_read_b64_tr_b16 v[148:149], v202 offset:4096
  ds_read_b64_tr_b16 v[150:151], v202 offset:5120
  buffer_load_dwordx4 a[184:187], v2, s[28:31], s73 offen offset:1024 sc1
  v_mfma_f32_32x32x16_bf16 v[48:63], a[236:239], v[152:155], v[48:63]
  s_waitcnt lgkmcnt(4)
  ds_read_b128 v[80:83], v208 offset:0
  ds_read_b128 v[84:87], v208 offset:32
  ds_read_b128 v[88:91], v208 offset:64
  ds_read_b128 v[92:95], v208 offset:96
  v_mfma_f32_32x32x16_bf16 v[64:79], a[236:239], v[156:159], v[64:79]
  buffer_load_dwordx4 a[188:191], v2, s[28:31], s74 offen offset:1024 sc1
  ds_read_b128 v[96:99], v208 offset:128
  ds_read_b128 v[100:103], v208 offset:160
  ds_read_b128 v[104:107], v208 offset:192
  ds_read_b128 v[108:111], v208 offset:224
  s_waitcnt lgkmcnt(10)
  v_mfma_f32_32x32x16_bf16 v[16:31], a[240:243], v[144:147], v[16:31]
  ds_read_b64_tr_b16 v[152:153], v201 offset:6144
  ds_read_b64_tr_b16 v[154:155], v201 offset:7168
  s_waitcnt lgkmcnt(10)
  v_mfma_f32_32x32x16_bf16 v[32:47], a[240:243], v[148:151], v[32:47]
  ds_read_b64_tr_b16 v[156:157], v202 offset:6144
  ds_read_b64_tr_b16 v[158:159], v202 offset:7168
  s_bfe_u32 s68, s1, 0x80018
  s_lshl_b32 s68, s68, 10
  s_add_u32 s73, s68, s96
  buffer_load_dwordx4 a[192:195], v2, s[28:31], s73 offen offset:0 sc1
  v_mfma_f32_32x32x16_bf16 v[48:63], a[244:247], v[144:147], v[48:63]
  v_mfma_f32_32x32x16_bf16 v[64:79], a[244:247], v[148:151], v[64:79]
  s_add_u32 s74, s73, 147456
  buffer_load_dwordx4 a[196:199], v2, s[28:31], s74 offen offset:0 sc1
  s_waitcnt lgkmcnt(2)
  v_mfma_f32_32x32x16_bf16 v[16:31], a[248:251], v[152:155], v[16:31]
  s_waitcnt lgkmcnt(0)
  v_mfma_f32_32x32x16_bf16 v[32:47], a[248:251], v[156:159], v[32:47]
  buffer_load_dwordx4 a[200:203], v2, s[28:31], s73 offen offset:1024 sc1
  v_mfma_f32_32x32x16_bf16 v[48:63], a[252:255], v[152:155], v[48:63]
  v_pk_mul_f32 v[16:17], v[16:17], v[80:81]
  v_pk_mul_f32 v[18:19], v[18:19], v[82:83]
  v_pk_mul_f32 v[20:21], v[20:21], v[84:85]
  v_pk_mul_f32 v[22:23], v[22:23], v[86:87]
  v_pk_mul_f32 v[24:25], v[24:25], v[88:89]
  v_pk_mul_f32 v[26:27], v[26:27], v[90:91]
  v_pk_mul_f32 v[28:29], v[28:29], v[92:93]
  v_pk_mul_f32 v[30:31], v[30:31], v[94:95]
  v_mfma_f32_32x32x16_bf16 v[64:79], a[252:255], v[156:159], v[64:79]
  buffer_load_dwordx4 a[204:207], v2, s[28:31], s74 offen offset:1024 sc1
  v_pk_mul_f32 v[32:33], v[32:33], v[80:81]
  v_pk_mul_f32 v[34:35], v[34:35], v[82:83]
  v_pk_mul_f32 v[36:37], v[36:37], v[84:85]
  v_pk_mul_f32 v[38:39], v[38:39], v[86:87]
  v_pk_mul_f32 v[40:41], v[40:41], v[88:89]
  v_pk_mul_f32 v[42:43], v[42:43], v[90:91]
  v_pk_mul_f32 v[44:45], v[44:45], v[92:93]
  v_pk_mul_f32 v[46:47], v[46:47], v[94:95]
  s_waitcnt vmcnt(15)
  v_mfma_f32_32x32x16_bf16 v[16:31], a[144:147], a[56:59], v[16:31]
  v_pk_mul_f32 v[48:49], v[48:49], v[96:97]
  v_pk_mul_f32 v[50:51], v[50:51], v[98:99]
  v_pk_mul_f32 v[52:53], v[52:53], v[100:101]
  v_pk_mul_f32 v[54:55], v[54:55], v[102:103]
  v_pk_mul_f32 v[56:57], v[56:57], v[104:105]
  v_pk_mul_f32 v[58:59], v[58:59], v[106:107]
  v_pk_mul_f32 v[60:61], v[60:61], v[108:109]
  v_pk_mul_f32 v[62:63], v[62:63], v[110:111]
  v_mfma_f32_32x32x16_bf16 v[32:47], a[144:147], a[60:63], v[32:47]
  v_pk_mul_f32 v[64:65], v[64:65], v[96:97]
  v_pk_mul_f32 v[66:67], v[66:67], v[98:99]
  v_pk_mul_f32 v[68:69], v[68:69], v[100:101]
  v_pk_mul_f32 v[70:71], v[70:71], v[102:103]
  v_pk_mul_f32 v[72:73], v[72:73], v[104:105]
  v_pk_mul_f32 v[74:75], v[74:75], v[106:107]
  v_pk_mul_f32 v[76:77], v[76:77], v[108:109]
  v_pk_mul_f32 v[78:79], v[78:79], v[110:111]
  s_waitcnt vmcnt(14)
  v_mfma_f32_32x32x16_bf16 v[48:63], a[148:151], a[56:59], v[48:63]
  v_mfma_f32_32x32x16_bf16 v[64:79], a[148:151], a[60:63], v[64:79]
  s_waitcnt vmcnt(13)
  v_mfma_f32_32x32x16_bf16 v[16:31], a[152:155], a[64:67], v[16:31]
  ds_read_b64_tr_b16 v[144:145], v201 offset:8192
  ds_read_b64_tr_b16 v[146:147], v201 offset:9216
  v_mfma_f32_32x32x16_bf16 v[32:47], a[152:155], a[68:71], v[32:47]
  ds_read_b64_tr_b16 v[148:149], v202 offset:8192
  ds_read_b64_tr_b16 v[150:151], v202 offset:9216
  s_waitcnt vmcnt(12)
  v_mfma_f32_32x32x16_bf16 v[48:63], a[156:159], a[64:67], v[48:63]
  v_mfma_f32_32x32x16_bf16 v[64:79], a[156:159], a[68:71], v[64:79]
  s_waitcnt vmcnt(11) lgkmcnt(2)
  v_mfma_f32_32x32x16_bf16 v[16:31], a[160:163], v[144:147], v[16:31]
  ds_read_b64_tr_b16 v[152:153], v201 offset:45056
  ds_read_b64_tr_b16 v[154:155], v201 offset:46080
  s_waitcnt lgkmcnt(2)
  v_mfma_f32_32x32x16_bf16 v[32:47], a[160:163], v[148:151], v[32:47]
  ds_read_b64_tr_b16 v[156:157], v202 offset:45056
  ds_read_b64_tr_b16 v[158:159], v202 offset:46080
  s_waitcnt vmcnt(10)
  v_mfma_f32_32x32x16_bf16 v[48:63], a[164:167], v[144:147], v[48:63]
  v_mfma_f32_32x32x16_bf16 v[64:79], a[164:167], v[148:151], v[64:79]
  s_waitcnt vmcnt(9) lgkmcnt(2)
  v_mfma_f32_32x32x16_bf16 v[16:31], a[168:171], v[152:155], v[16:31]
  ds_read_b64_tr_b16 v[144:145], v201 offset:47104
  ds_read_b64_tr_b16 v[146:147], v201 offset:48128
  s_waitcnt lgkmcnt(2)
  v_mfma_f32_32x32x16_bf16 v[32:47], a[168:171], v[156:159], v[32:47]
  ds_read_b64_tr_b16 v[148:149], v202 offset:47104
  ds_read_b64_tr_b16 v[150:151], v202 offset:48128
  s_waitcnt vmcnt(8)
  v_mfma_f32_32x32x16_bf16 v[48:63], a[172:175], v[152:155], v[48:63]
  v_mfma_f32_32x32x16_bf16 v[64:79], a[172:175], v[156:159], v[64:79]
  s_waitcnt vmcnt(7) lgkmcnt(2)
  v_mfma_f32_32x32x16_bf16 v[16:31], a[176:179], v[144:147], v[16:31]
  ds_read_b64_tr_b16 v[152:153], v201 offset:49152
  ds_read_b64_tr_b16 v[154:155], v201 offset:50176
  s_waitcnt lgkmcnt(2)
  v_mfma_f32_32x32x16_bf16 v[32:47], a[176:179], v[148:151], v[32:47]
  ds_read_b64_tr_b16 v[156:157], v202 offset:49152
  ds_read_b64_tr_b16 v[158:159], v202 offset:50176
  s_waitcnt vmcnt(6)
  v_mfma_f32_32x32x16_bf16 v[48:63], a[180:183], v[144:147], v[48:63]
  v_mfma_f32_32x32x16_bf16 v[64:79], a[180:183], v[148:151], v[64:79]
  s_waitcnt vmcnt(5) lgkmcnt(2)
  v_mfma_f32_32x32x16_bf16 v[16:31], a[184:187], v[152:155], v[16:31]
  ds_read_b64_tr_b16 v[144:145], v201 offset:51200
  ds_read_b64_tr_b16 v[146:147], v201 offset:52224
  s_waitcnt lgkmcnt(2)
  v_mfma_f32_32x32x16_bf16 v[32:47], a[184:187], v[156:159], v[32:47]
  ds_read_b64_tr_b16 v[148:149], v202 offset:51200
  ds_read_b64_tr_b16 v[150:151], v202 offset:52224
  s_waitcnt vmcnt(4)
  v_mfma_f32_32x32x16_bf16 v[48:63], a[188:191], v[152:155], v[48:63]
  v_mfma_f32_32x32x16_bf16 v[64:79], a[188:191], v[156:159], v[64:79]
  s_waitcnt vmcnt(3) lgkmcnt(2)
  v_mfma_f32_32x32x16_bf16 v[16:31], a[192:195], v[144:147], v[16:31]
  ds_read_b64_tr_b16 v[152:153], v201 offset:53248
  ds_read_b64_tr_b16 v[154:155], v201 offset:54272
  s_waitcnt lgkmcnt(2)
  v_mfma_f32_32x32x16_bf16 v[32:47], a[192:195], v[148:151], v[32:47]
  ds_read_b64_tr_b16 v[156:157], v202 offset:53248
  ds_read_b64_tr_b16 v[158:159], v202 offset:54272
  s_waitcnt vmcnt(2)
  v_mfma_f32_32x32x16_bf16 v[48:63], a[196:199], v[144:147], v[48:63]
  v_mfma_f32_32x32x16_bf16 v[64:79], a[196:199], v[148:151], v[64:79]
  s_waitcnt vmcnt(1) lgkmcnt(2)
  v_mfma_f32_32x32x16_bf16 v[16:31], a[200:203], v[152:155], v[16:31]
  s_mov_b32 m0, s52
  s_waitcnt lgkmcnt(0)
  v_mfma_f32_32x32x16_bf16 v[32:47], a[200:203], v[156:159], v[32:47]
  s_waitcnt vmcnt(0)
  v_mfma_f32_32x32x16_bf16 v[48:63], a[204:207], v[152:155], v[48:63]
  ds_write_addtid_b32 v16 offset:0
  ds_write_addtid_b32 v17 offset:256
  ds_write_addtid_b32 v18 offset:512
  ds_write_addtid_b32 v19 offset:768
  ds_write_addtid_b32 v20 offset:1024
  ds_write_addtid_b32 v21 offset:1280
  ds_write_addtid_b32 v22 offset:1536
  v_mfma_f32_32x32x16_bf16 v[64:79], a[204:207], v[156:159], v[64:79]
  ds_write_addtid_b32 v23 offset:1792
  ds_write_addtid_b32 v24 offset:2048
  ds_write_addtid_b32 v25 offset:2304
  ds_write_addtid_b32 v26 offset:2560
  ds_write_addtid_b32 v27 offset:2816
  ds_write_addtid_b32 v28 offset:3072
  ds_write_addtid_b32 v29 offset:3328
  ds_write_addtid_b32 v30 offset:3584
  ds_write_addtid_b32 v31 offset:3840
  ds_write_addtid_b32 v32 offset:4096
  ds_write_addtid_b32 v33 offset:4352
  ds_write_addtid_b32 v34 offset:4608
  ds_write_addtid_b32 v35 offset:4864
  ds_write_addtid_b32 v36 offset:5120
  ds_write_addtid_b32 v37 offset:5376
  ds_write_addtid_b32 v38 offset:5632
  ds_write_addtid_b32 v39 offset:5888
  ds_write_addtid_b32 v40 offset:6144
  ds_write_addtid_b32 v41 offset:6400
  ds_write_addtid_b32 v42 offset:6656
  ds_write_addtid_b32 v43 offset:6912
  ds_write_addtid_b32 v44 offset:7168
  ds_write_addtid_b32 v45 offset:7424
  ds_write_addtid_b32 v46 offset:7680
  ds_write_addtid_b32 v47 offset:7936
  ds_write_addtid_b32 v48 offset:8192
  ds_write_addtid_b32 v49 offset:8448
  ds_write_addtid_b32 v50 offset:8704
  ds_write_addtid_b32 v51 offset:8960
  ds_write_addtid_b32 v52 offset:9216
  ds_write_addtid_b32 v53 offset:9472
  ds_write_addtid_b32 v54 offset:9728
  ds_write_addtid_b32 v55 offset:9984
  ds_write_addtid_b32 v56 offset:10240
  ds_write_addtid_b32 v57 offset:10496
  ds_write_addtid_b32 v58 offset:10752
  ds_write_addtid_b32 v59 offset:11008
  ds_write_addtid_b32 v60 offset:11264
  ds_write_addtid_b32 v61 offset:11520
  ds_write_addtid_b32 v62 offset:11776
  ds_write_addtid_b32 v63 offset:12032
  ds_write_addtid_b32 v64 offset:12288
  ds_write_addtid_b32 v65 offset:12544
  ds_write_addtid_b32 v66 offset:12800
  ds_write_addtid_b32 v67 offset:13056
  ds_write_addtid_b32 v68 offset:13312
  ds_write_addtid_b32 v69 offset:13568
  ds_write_addtid_b32 v70 offset:13824
  ds_write_addtid_b32 v71 offset:14080
  ds_write_addtid_b32 v72 offset:14336
  ds_write_addtid_b32 v73 offset:14592
  ds_write_addtid_b32 v74 offset:14848
  ds_write_addtid_b32 v75 offset:15104
  ds_write_addtid_b32 v76 offset:15360
  ds_write_addtid_b32 v77 offset:15616
  ds_write_addtid_b32 v78 offset:15872
  ds_write_addtid_b32 v79 offset:16128
  s_waitcnt lgkmcnt(0)
  s_barrier
  ds_read_b128 v[80:83], v210 offset:0
  ds_read_b128 v[84:87], v210 offset:16384
  ds_read_b128 v[88:91], v210 offset:32768
  ds_read_b128 v[92:95], v210 offset:49152
  ds_read_b128 v[96:99], v210 offset:4096
  ds_read_b128 v[100:103], v210 offset:20480
  ds_read_b128 v[104:107], v210 offset:36864
  ds_read_b128 v[108:111], v210 offset:53248
  ds_read_b128 v[112:115], v210 offset:1024
  ds_read_b128 v[116:119], v210 offset:17408
  ds_read_b128 v[120:123], v210 offset:33792
  ds_read_b128 v[124:127], v210 offset:50176
  ds_read_b128 v[128:131], v210 offset:5120
  ds_read_b128 v[132:135], v210 offset:21504
  ds_read_b128 v[136:139], v210 offset:37888
  ds_read_b128 v[140:143], v210 offset:54272
  s_waitcnt lgkmcnt(14)
  v_pk_add_f32 v[80:81], v[80:81], v[84:85]
  s_waitcnt lgkmcnt(12)
  v_pk_add_f32 v[88:89], v[88:89], v[92:93]
  v_pk_add_f32 v[82:83], v[82:83], v[86:87]
  v_pk_add_f32 v[90:91], v[90:91], v[94:95]
  v_pk_add_f32 v[80:81], v[80:81], v[88:89]
  v_pk_add_f32 v[82:83], v[82:83], v[90:91]
  v_cvt_pk_bf16_f32 v80, v80, v81
  v_cvt_pk_bf16_f32 v81, v82, v83
  buffer_store_dwordx2 v[80:81], v211, s[32:35], s98 offen offset:0
  s_waitcnt lgkmcnt(10)
  v_pk_add_f32 v[96:97], v[96:97], v[100:101]
  s_waitcnt lgkmcnt(8)
  v_pk_add_f32 v[104:105], v[104:105], v[108:109]
  v_pk_add_f32 v[98:99], v[98:99], v[102:103]
  v_pk_add_f32 v[106:107], v[106:107], v[110:111]
  v_pk_add_f32 v[96:97], v[96:97], v[104:105]
  v_pk_add_f32 v[98:99], v[98:99], v[106:107]
  v_cvt_pk_bf16_f32 v96, v96, v97
  v_cvt_pk_bf16_f32 v97, v98, v99
  buffer_store_dwordx2 v[96:97], v211, s[32:35], s98 offen offset:64
  s_waitcnt lgkmcnt(6)
  v_pk_add_f32 v[112:113], v[112:113], v[116:117]
  s_waitcnt lgkmcnt(4)
  v_pk_add_f32 v[120:121], v[120:121], v[124:125]
  v_pk_add_f32 v[114:115], v[114:115], v[118:119]
  v_pk_add_f32 v[122:123], v[122:123], v[126:127]
  v_pk_add_f32 v[112:113], v[112:113], v[120:121]
  v_pk_add_f32 v[114:115], v[114:115], v[122:123]
  v_cvt_pk_bf16_f32 v112, v112, v113
  v_cvt_pk_bf16_f32 v113, v114, v115
  buffer_store_dwordx2 v[112:113], v211, s[32:35], s99 offen offset:0
  s_waitcnt lgkmcnt(2)
  v_pk_add_f32 v[128:129], v[128:129], v[132:133]
  s_waitcnt lgkmcnt(0)
  v_pk_add_f32 v[136:137], v[136:137], v[140:141]
  v_pk_add_f32 v[130:131], v[130:131], v[134:135]
  v_pk_add_f32 v[138:139], v[138:139], v[142:143]
  v_pk_add_f32 v[128:129], v[128:129], v[136:137]
  v_pk_add_f32 v[130:131], v[130:131], v[138:139]
  v_cvt_pk_bf16_f32 v128, v128, v129
  v_cvt_pk_bf16_f32 v129, v130, v131
  buffer_store_dwordx2 v[128:129], v211, s[32:35], s99 offen offset:64
  s_endpgm
L_exit:
  s_endpgm
.section .rodata,"a"
.p2align 6
.amdhsa_kernel gated_mix__linear_attn_block__dense_activation_silu__prompt_kernel
  .amdhsa_next_free_vgpr 512
  .amdhsa_next_free_sgpr 102
  .amdhsa_accum_offset 256
  .amdhsa_group_segment_fixed_size 0
  .amdhsa_kernarg_size 80
  .amdhsa_user_sgpr_count 2
  .amdhsa_user_sgpr_kernarg_segment_ptr 1
  .amdhsa_system_sgpr_workgroup_id_x 1
  .amdhsa_float_denorm_mode_32 3
.end_amdhsa_kernel
```
